```python
import torch

def _softmax(x, axis=-1):
    return torch.softmax(x, dim=axis)
def _gelu(x):
    return torch.nn.functional.gelu(x, approximate="tanh")
def _silu(x):
    return torch.nn.functional.silu(x)
def _sigmoid(x):
    return torch.sigmoid(x)
def _layernorm(x, axis=-1, eps=1e-5):
    m = x.mean(dim=axis, keepdim=True)
    v = x.var(dim=axis, keepdim=True, unbiased=False)
    return (x - m) / torch.sqrt(v + eps)
def _scatter_add(tgt, idx, src, axis=0):
    return tgt.clone().index_add_(axis, idx, src)
def _segment_sum(src, seg, n):
    out = torch.zeros((n,) + src.shape[1:], dtype=src.dtype)
    return out.index_add_(0, seg, src)
def _pad(x, pw):
    flat = tuple(v for pair in reversed(pw) for v in pair)
    return torch.nn.functional.pad(x, flat)

kernel_name = 'standalone__controlnet__diffusion'

def setup_inputs():

    _w = (lambda a: (lambda t: t.to(torch.bfloat16) if t.is_floating_point() else t)(torch.as_tensor(a)))
    B, HW, C = 2, 32, 512
    sc = C ** -0.5
    return {
        "x_frozen": _w((lambda *s: torch.randn(*s, dtype=torch.bfloat16) * 0.4)(B, HW, HW, C)),
        "x": _w((lambda *s: torch.randn(*s, dtype=torch.bfloat16) * 0.8)(B, HW, HW, C)),
        "c": _w((lambda *s: torch.randn(*s, dtype=torch.bfloat16) * 1.6)(B, HW, HW, C)),
        "w_z1": _w((lambda *s: torch.randn(*s, dtype=torch.bfloat16) * 1.6)(C, C) * sc),
        "w_z2": _w((lambda *s: torch.randn(*s, dtype=torch.bfloat16) * 0.8)(C, C) * sc),
        "w_conv": _w((lambda *s: torch.randn(*s, dtype=torch.bfloat16) * 0.8)(3, 3, C, C) * sc / 3.0),
    }

def reference(x_frozen, x, c, w_z1, w_z2, w_conv):
    B, H, W, C = x.shape
    h_in = x + torch.einsum("bhwc,cd->bhwd", c, w_z1)
    h = _silu(_layernorm(h_in, axis=-1))
    hp = _pad(h, ((0, 0), (1, 1), (1, 1), (0, 0)))
    acc = h * 0.0
    for di in range(3):
        for dj in range(3):
            acc = acc + torch.einsum("bhwc,cd->bhwd", hp[:, di:di + H, dj:dj + W, :], w_conv[di, dj])
    h = h_in + acc
    return x_frozen + torch.einsum("bhwc,cd->bhwd", h, w_z2)
```

```asm
; @launch kernel=fused_kernel grid=(256,1,1) block=(256,1,1) lds=163840
.amdgcn_target "amdgcn-amd-amdhsa--gfx950"
.text
.globl fused_kernel
.p2align 8
.type fused_kernel,@function
fused_kernel:
    s_cmp_ge_u32 s2, 256
    s_cbranch_scc1 fused_kernel_end
    s_load_dwordx8 s[4:11], s[0:1], 8
    s_load_dwordx8 s[44:51], s[0:1], 40
    s_load_dwordx2 s[40:41], s[0:1], 0
    v_and_b32 v1, 63, v0
    v_lshrrev_b32 v2, 6, v0
    s_nop 0
    v_readfirstlane_b32 s32, v2
    s_getpc_b64 s[12:13]
    s_and_b32 s12, s12, 0xffffff00
    s_and_b32 s13, s13, 0xffff
    s_mov_b32 s14, fused_kernel_end-fused_kernel
    s_mov_b32 s15, 0x00020000
    s_lshr_b32 s35, s2, 3
    s_sub_u32 s35, s35, 0
    s_cmp_ge_u32 s35, 2
    s_cbranch_scc1 fused_kernel_cpf
    s_lshl_b32 s35, s35, 15
    v_lshlrev_b32 v2, 7, v0
    buffer_load_dword v255, v2, s[12:15], s35 offen
fused_kernel_cpf:
    s_and_b32 s35, s2, 7
    s_lshr_b32 s36, s2, 3
    s_and_b32 s33, s36, 3
    s_lshr_b32 s36, s36, 2
    s_lshl_b32 s34, s35, 2
    s_lshr_b32 s37, s36, 1
    s_add_u32 s34, s34, s37
    s_and_b32 s35, s36, 1
    s_lshl_b32 s35, s35, 2
    v_lshrrev_b32 v2, 3, v1
    s_lshl_b32 s37, s32, 3
    v_add_u32 v4, s37, v2
    v_lshrrev_b32 v2, 1, v4
    v_and_b32 v2, 7, v2
    v_and_b32 v3, 7, v1
    v_xor_b32 v2, v2, v3
    v_lshlrev_b32 v2, 4, v2
    v_lshl_add_u32 v4, v4, 10, v2
    v_lshrrev_b32 v2, 4, v1
    v_lshlrev_b32 v3, 2, v2
    v_and_b32 v5, 15, v1
    v_xor_b32 v5, v5, v3
    v_lshlrev_b32 v5, 4, v5
    s_lshl_b32 s37, s32, 2
    v_add_u32 v2, s37, v2
    v_lshl_add_u32 v5, v2, 10, v5
    s_lshl_b32 s37, s33, 8
    v_add_u32 v5, s37, v5
    s_lshl_b32 s39, s32, 10
    v_mov_b32 v22, 0
    s_cmp_ge_u32 s35, 4
    s_cbranch_scc1 fused_kernel_P
    s_lshl_b32 s38, s34, 16
    v_lshrrev_b32 v2, 4, v1
    s_lshl_b32 s37, s32, 2
    v_add_u32 v2, s37, v2
    v_and_b32 v3, 15, v1
    v_xor_b32 v3, v3, v2
    v_lshlrev_b32 v3, 4, v3
    v_lshl_add_u32 v2, v2, 10, v3
    s_lshl_b32 s37, s33, 8
    v_add_u32 v20, s37, v2
    s_waitcnt lgkmcnt(0)
    s_mov_b32 s12, s6
    s_and_b32 s13, s7, 0xffff
    s_mov_b32 s14, 0x200000
    s_mov_b32 s15, 0x00020000
    s_mov_b32 s16, s8
    s_and_b32 s17, s9, 0xffff
    s_mov_b32 s18, 0x80000
    s_mov_b32 s19, 0x00020000
    s_mov_b32 s24, s4
    s_and_b32 s25, s5, 0xffff
    s_mov_b32 s26, 0x200000
    s_mov_b32 s27, 0x00020000
    s_add_u32 m0, s39, 0
    s_add_u32 s42, s38, 0
    buffer_load_dwordx4 v4, s[12:15], s42 offen lds
    s_add_u32 m0, s39, 4096
    s_add_u32 s42, s38, 32768
    buffer_load_dwordx4 v4, s[12:15], s42 offen lds
    s_add_u32 m0, s39, 8192
    s_mov_b32 s43, 0
    buffer_load_dwordx4 v5, s[16:19], s43 offen lds
    s_add_u32 m0, s39, 12288
    s_mov_b32 s43, 16384
    buffer_load_dwordx4 v5, s[16:19], s43 offen lds
    s_add_u32 m0, s39, 16384
    s_mov_b32 s43, 32768
    buffer_load_dwordx4 v5, s[16:19], s43 offen lds
    s_add_u32 m0, s39, 20480
    s_mov_b32 s43, 49152
    buffer_load_dwordx4 v5, s[16:19], s43 offen lds
    s_mov_b32 s28, s48
    s_and_b32 s29, s49, 0xffff
    s_mov_b32 s30, 0x100
    s_mov_b32 s31, 0x00020000
    s_or_b32 s35, s2, s32
    s_cmp_lg_u32 s35, 0
    s_cbranch_scc1 fused_kernel_nn
    s_memrealtime s[96:97]
    s_waitcnt lgkmcnt(0)
    s_or_b32 s96, s96, 1
    v_mov_b32 v2, s96
    buffer_store_dword v2, v22, s[28:31], 0 offen sc1
fused_kernel_nn:
    s_add_u32 m0, s39, 24576
    s_add_u32 s42, s38, 128
    buffer_load_dwordx4 v4, s[12:15], s42 offen lds
    s_add_u32 m0, s39, 28672
    s_add_u32 s42, s38, 32896
    buffer_load_dwordx4 v4, s[12:15], s42 offen lds
    s_add_u32 m0, s39, 32768
    s_mov_b32 s43, 65536
    buffer_load_dwordx4 v5, s[16:19], s43 offen lds
    s_add_u32 m0, s39, 36864
    s_mov_b32 s43, 81920
    buffer_load_dwordx4 v5, s[16:19], s43 offen lds
    s_add_u32 m0, s39, 40960
    s_mov_b32 s43, 98304
    buffer_load_dwordx4 v5, s[16:19], s43 offen lds
    s_add_u32 m0, s39, 45056
    s_mov_b32 s43, 114688
    buffer_load_dwordx4 v5, s[16:19], s43 offen lds
    s_add_u32 m0, s39, 49152
    s_add_u32 s42, s38, 256
    buffer_load_dwordx4 v4, s[12:15], s42 offen lds
    s_add_u32 m0, s39, 53248
    s_add_u32 s42, s38, 33024
    buffer_load_dwordx4 v4, s[12:15], s42 offen lds
    s_add_u32 m0, s39, 57344
    s_mov_b32 s43, 131072
    buffer_load_dwordx4 v5, s[16:19], s43 offen lds
    s_add_u32 m0, s39, 61440
    s_mov_b32 s43, 147456
    buffer_load_dwordx4 v5, s[16:19], s43 offen lds
    s_add_u32 m0, s39, 65536
    s_mov_b32 s43, 163840
    buffer_load_dwordx4 v5, s[16:19], s43 offen lds
    s_add_u32 m0, s39, 69632
    s_mov_b32 s43, 180224
    buffer_load_dwordx4 v5, s[16:19], s43 offen lds
    v_and_b32 v7, 31, v1
    v_lshrrev_b32 v8, 5, v1
    v_lshlrev_b32 v9, 4, v1
    v_lshrrev_b32 v2, 1, v7
    v_and_b32 v2, 7, v2
    v_xor_b32 v2, v2, v8
    v_lshlrev_b32 v2, 4, v2
    v_lshl_add_u32 v10, v7, 7, v2
    s_lshr_b32 s37, s32, 1
    s_lshl_b32 s37, s37, 12
    v_add_u32 v10, s37, v10
    v_xor_b32 v11, 32, v10
    v_xor_b32 v12, 64, v10
    v_xor_b32 v13, 96, v10
    v_bfe_u32 v2, v1, 2, 2
    v_lshl_add_u32 v3, v8, 3, v2
    v_lshlrev_b32 v6, 8, v3
    s_and_b32 s37, s32, 1
    s_lshl_b32 s37, s37, 1
    v_xor_b32 v2, s37, v2
    v_lshl_add_u32 v6, v2, 6, v6
    v_bfe_u32 v2, v1, 4, 1
    v_lshl_add_u32 v6, v2, 5, v6
    v_and_b32 v2, 3, v1
    v_lshl_add_u32 v6, v2, 3, v6
    s_mov_b32 s20, s50
    s_and_b32 s21, s51, 0xffff
    s_mov_b32 s22, 0x1000000
    s_mov_b32 s23, 0x00020000
    v_add_u32 v14, 0, v10
    v_add_u32 v15, 0, v11
    v_add_u32 v16, 0, v12
    v_add_u32 v17, 0, v13
    v_add_u32 v18, 8192, v6
    v_xor_b32 v23, 64, v18
    s_waitcnt vmcnt(12)
    s_barrier
    ds_read_b128 v[24:27], v14
    ds_read_b64_tr_b16 v[64:65], v18 offset:0
    ds_read_b64_tr_b16 v[66:67], v18 offset:1024
    ds_read_b64_tr_b16 v[68:69], v23 offset:0
    ds_read_b64_tr_b16 v[70:71], v23 offset:1024
    s_waitcnt lgkmcnt(2)
    v_mfma_f32_32x32x16_bf16 v[80:95], v[64:67], v[24:27], 0
    ds_read_b128 v[44:47], v15
    ds_read_b64_tr_b16 v[72:73], v18 offset:4096
    ds_read_b64_tr_b16 v[74:75], v18 offset:5120
    s_add_u32 m0, s39, 73728
    s_add_u32 s42, s38, 384
    buffer_load_dwordx4 v4, s[12:15], s42 offen lds
    s_waitcnt lgkmcnt(3)
    v_mfma_f32_32x32x16_bf16 v[96:111], v[68:71], v[24:27], 0
    ds_read_b64_tr_b16 v[76:77], v23 offset:4096
    ds_read_b64_tr_b16 v[78:79], v23 offset:5120
    s_add_u32 m0, s39, 77824
    s_add_u32 s42, s38, 33152
    buffer_load_dwordx4 v4, s[12:15], s42 offen lds
    s_waitcnt lgkmcnt(2)
    v_mfma_f32_32x32x16_bf16 v[80:95], v[72:75], v[44:47], v[80:95]
    ds_read_b128 v[24:27], v16
    ds_read_b64_tr_b16 v[64:65], v18 offset:8192
    ds_read_b64_tr_b16 v[66:67], v18 offset:9216
    s_add_u32 m0, s39, 81920
    s_mov_b32 s43, 196608
    buffer_load_dwordx4 v5, s[16:19], s43 offen lds
    s_waitcnt lgkmcnt(3)
    v_mfma_f32_32x32x16_bf16 v[96:111], v[76:79], v[44:47], v[96:111]
    ds_read_b64_tr_b16 v[68:69], v23 offset:8192
    ds_read_b64_tr_b16 v[70:71], v23 offset:9216
    s_add_u32 m0, s39, 86016
    s_mov_b32 s43, 212992
    buffer_load_dwordx4 v5, s[16:19], s43 offen lds
    s_waitcnt lgkmcnt(2)
    v_mfma_f32_32x32x16_bf16 v[80:95], v[64:67], v[24:27], v[80:95]
    ds_read_b128 v[44:47], v17
    ds_read_b64_tr_b16 v[72:73], v18 offset:12288
    ds_read_b64_tr_b16 v[74:75], v18 offset:13312
    s_add_u32 m0, s39, 90112
    s_mov_b32 s43, 229376
    buffer_load_dwordx4 v5, s[16:19], s43 offen lds
    s_waitcnt lgkmcnt(3)
    v_mfma_f32_32x32x16_bf16 v[96:111], v[68:71], v[24:27], v[96:111]
    ds_read_b64_tr_b16 v[76:77], v23 offset:12288
    ds_read_b64_tr_b16 v[78:79], v23 offset:13312
    s_add_u32 m0, s39, 94208
    s_mov_b32 s43, 245760
    buffer_load_dwordx4 v5, s[16:19], s43 offen lds
    s_waitcnt lgkmcnt(0)
    s_waitcnt vmcnt(12)
    s_barrier
    v_add_u32 v14, 24576, v10
    v_add_u32 v15, 24576, v11
    v_add_u32 v16, 24576, v12
    v_add_u32 v17, 24576, v13
    v_add_u32 v18, 32768, v6
    v_xor_b32 v23, 64, v18
    v_mfma_f32_32x32x16_bf16 v[80:95], v[72:75], v[44:47], v[80:95]
    ds_read_b128 v[24:27], v14
    ds_read_b64_tr_b16 v[64:65], v18 offset:0
    ds_read_b64_tr_b16 v[66:67], v18 offset:1024
    s_add_u32 m0, s39, 98304
    s_add_u32 s42, s38, 512
    buffer_load_dwordx4 v4, s[12:15], s42 offen lds
    v_mfma_f32_32x32x16_bf16 v[96:111], v[76:79], v[44:47], v[96:111]
    ds_read_b64_tr_b16 v[68:69], v23 offset:0
    ds_read_b64_tr_b16 v[70:71], v23 offset:1024
    s_add_u32 m0, s39, 102400
    s_add_u32 s42, s38, 33280
    buffer_load_dwordx4 v4, s[12:15], s42 offen lds
    s_lshr_b32 s35, s32, 1
    s_and_b32 s36, s32, 1
    s_lshl_b32 s37, s35, 13
    s_add_u32 s37, s37, 147456
    v_and_b32 v2, 15, v7
    s_lshl_b32 s42, s36, 3
    v_xor_b32 v2, s42, v2
    v_lshlrev_b32 v2, 4, v2
    v_lshl_add_u32 v2, v7, 8, v2
    v_lshl_add_u32 v2, v8, 3, v2
    v_add_u32 v220, s37, v2
    s_lshl_b32 s37, s35, 15
    s_add_u32 s37, s37, s38
    s_lshl_b32 s42, s33, 13
    s_add_u32 s37, s37, s42
    s_lshl_b32 s42, s36, 12
    s_add_u32 s37, s37, s42
    v_add_u32 v19, s37, v9
    s_lshl_b32 s42, s34, 1
    s_add_u32 s42, s42, s35
    s_lshl_b32 s42, s42, 12
    s_add_u32 s42, s42, 10485760
    v_lshlrev_b32 v222, 4, v7
    v_add_u32 v222, s42, v222
    v_lshl_add_u32 v221, v8, 11, v222
    s_lshl_b32 s93, s33, 1
    s_add_u32 s93, s93, s36
    s_lshl_b32 s93, s93, 9
    s_waitcnt lgkmcnt(2)
    v_mfma_f32_32x32x16_bf16 v[80:95], v[64:67], v[24:27], v[80:95]
    ds_read_b128 v[44:47], v15
    ds_read_b64_tr_b16 v[72:73], v18 offset:4096
    ds_read_b64_tr_b16 v[74:75], v18 offset:5120
    s_add_u32 m0, s39, 106496
    s_mov_b32 s43, 262144
    buffer_load_dwordx4 v5, s[16:19], s43 offen lds
    s_waitcnt lgkmcnt(3)
    v_mfma_f32_32x32x16_bf16 v[96:111], v[68:71], v[24:27], v[96:111]
    ds_read_b64_tr_b16 v[76:77], v23 offset:4096
    ds_read_b64_tr_b16 v[78:79], v23 offset:5120
    s_add_u32 m0, s39, 110592
    s_mov_b32 s43, 278528
    buffer_load_dwordx4 v5, s[16:19], s43 offen lds
    s_waitcnt lgkmcnt(2)
    v_mfma_f32_32x32x16_bf16 v[80:95], v[72:75], v[44:47], v[80:95]
    ds_read_b128 v[24:27], v16
    ds_read_b64_tr_b16 v[64:65], v18 offset:8192
    ds_read_b64_tr_b16 v[66:67], v18 offset:9216
    s_add_u32 m0, s39, 114688
    s_mov_b32 s43, 294912
    buffer_load_dwordx4 v5, s[16:19], s43 offen lds
    s_waitcnt lgkmcnt(3)
    v_mfma_f32_32x32x16_bf16 v[96:111], v[76:79], v[44:47], v[96:111]
    ds_read_b64_tr_b16 v[68:69], v23 offset:8192
    ds_read_b64_tr_b16 v[70:71], v23 offset:9216
    s_add_u32 m0, s39, 118784
    s_mov_b32 s43, 311296
    buffer_load_dwordx4 v5, s[16:19], s43 offen lds
    s_waitcnt lgkmcnt(2)
    v_mfma_f32_32x32x16_bf16 v[80:95], v[64:67], v[24:27], v[80:95]
    ds_read_b128 v[44:47], v17
    ds_read_b64_tr_b16 v[72:73], v18 offset:12288
    ds_read_b64_tr_b16 v[74:75], v18 offset:13312
    s_add_u32 m0, s39, 147456
    s_add_u32 s42, s38, 0
    buffer_load_dwordx4 v20, s[24:27], s42 offen lds
    s_waitcnt lgkmcnt(3)
    v_mfma_f32_32x32x16_bf16 v[96:111], v[68:71], v[24:27], v[96:111]
    ds_read_b64_tr_b16 v[76:77], v23 offset:12288
    ds_read_b64_tr_b16 v[78:79], v23 offset:13312
    s_add_u32 m0, s39, 151552
    s_add_u32 s42, s38, 16384
    buffer_load_dwordx4 v20, s[24:27], s42 offen lds
    s_waitcnt lgkmcnt(0)
    s_waitcnt vmcnt(14)
    s_barrier
    v_add_u32 v14, 49152, v10
    v_add_u32 v15, 49152, v11
    v_add_u32 v16, 49152, v12
    v_add_u32 v17, 49152, v13
    v_add_u32 v18, 57344, v6
    v_xor_b32 v23, 64, v18
    v_mfma_f32_32x32x16_bf16 v[80:95], v[72:75], v[44:47], v[80:95]
    ds_read_b128 v[24:27], v14
    ds_read_b64_tr_b16 v[64:65], v18 offset:0
    ds_read_b64_tr_b16 v[66:67], v18 offset:1024
    s_add_u32 m0, s39, 155648
    s_add_u32 s42, s38, 32768
    buffer_load_dwordx4 v20, s[24:27], s42 offen lds
    v_mfma_f32_32x32x16_bf16 v[96:111], v[76:79], v[44:47], v[96:111]
    ds_read_b64_tr_b16 v[68:69], v23 offset:0
    ds_read_b64_tr_b16 v[70:71], v23 offset:1024
    s_add_u32 m0, s39, 159744
    s_add_u32 s42, s38, 49152
    buffer_load_dwordx4 v20, s[24:27], s42 offen lds
    s_waitcnt lgkmcnt(2)
    v_mfma_f32_32x32x16_bf16 v[80:95], v[64:67], v[24:27], v[80:95]
    ds_read_b128 v[44:47], v15
    ds_read_b64_tr_b16 v[72:73], v18 offset:4096
    ds_read_b64_tr_b16 v[74:75], v18 offset:5120
    s_add_u32 m0, s39, 122880
    s_add_u32 s42, s38, 640
    buffer_load_dwordx4 v4, s[12:15], s42 offen lds
    s_waitcnt lgkmcnt(3)
    v_mfma_f32_32x32x16_bf16 v[96:111], v[68:71], v[24:27], v[96:111]
    ds_read_b64_tr_b16 v[76:77], v23 offset:4096
    ds_read_b64_tr_b16 v[78:79], v23 offset:5120
    s_add_u32 m0, s39, 126976
    s_add_u32 s42, s38, 33408
    buffer_load_dwordx4 v4, s[12:15], s42 offen lds
    s_waitcnt lgkmcnt(2)
    v_mfma_f32_32x32x16_bf16 v[80:95], v[72:75], v[44:47], v[80:95]
    ds_read_b128 v[24:27], v16
    ds_read_b64_tr_b16 v[64:65], v18 offset:8192
    ds_read_b64_tr_b16 v[66:67], v18 offset:9216
    s_add_u32 m0, s39, 131072
    s_mov_b32 s43, 327680
    buffer_load_dwordx4 v5, s[16:19], s43 offen lds
    s_waitcnt lgkmcnt(3)
    v_mfma_f32_32x32x16_bf16 v[96:111], v[76:79], v[44:47], v[96:111]
    ds_read_b64_tr_b16 v[68:69], v23 offset:8192
    ds_read_b64_tr_b16 v[70:71], v23 offset:9216
    s_add_u32 m0, s39, 135168
    s_mov_b32 s43, 344064
    buffer_load_dwordx4 v5, s[16:19], s43 offen lds
    s_waitcnt lgkmcnt(2)
    v_mfma_f32_32x32x16_bf16 v[80:95], v[64:67], v[24:27], v[80:95]
    ds_read_b128 v[44:47], v17
    ds_read_b64_tr_b16 v[72:73], v18 offset:12288
    ds_read_b64_tr_b16 v[74:75], v18 offset:13312
    s_add_u32 m0, s39, 139264
    s_mov_b32 s43, 360448
    buffer_load_dwordx4 v5, s[16:19], s43 offen lds
    s_waitcnt lgkmcnt(3)
    v_mfma_f32_32x32x16_bf16 v[96:111], v[68:71], v[24:27], v[96:111]
    ds_read_b64_tr_b16 v[76:77], v23 offset:12288
    ds_read_b64_tr_b16 v[78:79], v23 offset:13312
    s_add_u32 m0, s39, 143360
    s_mov_b32 s43, 376832
    buffer_load_dwordx4 v5, s[16:19], s43 offen lds
    s_waitcnt lgkmcnt(0)
    s_waitcnt vmcnt(16)
    s_barrier
    v_add_u32 v14, 73728, v10
    v_add_u32 v15, 73728, v11
    v_add_u32 v16, 73728, v12
    v_add_u32 v17, 73728, v13
    v_add_u32 v18, 81920, v6
    v_xor_b32 v23, 64, v18
    v_mfma_f32_32x32x16_bf16 v[80:95], v[72:75], v[44:47], v[80:95]
    ds_read_b128 v[24:27], v14
    ds_read_b64_tr_b16 v[64:65], v18 offset:0
    ds_read_b64_tr_b16 v[66:67], v18 offset:1024
    s_add_u32 m0, s39, 0
    s_add_u32 s42, s38, 768
    buffer_load_dwordx4 v4, s[12:15], s42 offen lds
    v_mfma_f32_32x32x16_bf16 v[96:111], v[76:79], v[44:47], v[96:111]
    ds_read_b64_tr_b16 v[68:69], v23 offset:0
    ds_read_b64_tr_b16 v[70:71], v23 offset:1024
    s_add_u32 m0, s39, 4096
    s_add_u32 s42, s38, 33536
    buffer_load_dwordx4 v4, s[12:15], s42 offen lds
    s_waitcnt lgkmcnt(2)
    v_mfma_f32_32x32x16_bf16 v[80:95], v[64:67], v[24:27], v[80:95]
    ds_read_b128 v[44:47], v15
    ds_read_b64_tr_b16 v[72:73], v18 offset:4096
    ds_read_b64_tr_b16 v[74:75], v18 offset:5120
    s_add_u32 m0, s39, 8192
    s_mov_b32 s43, 393216
    buffer_load_dwordx4 v5, s[16:19], s43 offen lds
    s_waitcnt lgkmcnt(3)
    v_mfma_f32_32x32x16_bf16 v[96:111], v[68:71], v[24:27], v[96:111]
    ds_read_b64_tr_b16 v[76:77], v23 offset:4096
    ds_read_b64_tr_b16 v[78:79], v23 offset:5120
    s_add_u32 m0, s39, 12288
    s_mov_b32 s43, 409600
    buffer_load_dwordx4 v5, s[16:19], s43 offen lds
    s_waitcnt lgkmcnt(2)
    v_mfma_f32_32x32x16_bf16 v[80:95], v[72:75], v[44:47], v[80:95]
    ds_read_b128 v[24:27], v16
    ds_read_b64_tr_b16 v[64:65], v18 offset:8192
    ds_read_b64_tr_b16 v[66:67], v18 offset:9216
    s_add_u32 m0, s39, 16384
    s_mov_b32 s43, 425984
    buffer_load_dwordx4 v5, s[16:19], s43 offen lds
    s_waitcnt lgkmcnt(3)
    v_mfma_f32_32x32x16_bf16 v[96:111], v[76:79], v[44:47], v[96:111]
    ds_read_b64_tr_b16 v[68:69], v23 offset:8192
    ds_read_b64_tr_b16 v[70:71], v23 offset:9216
    s_add_u32 m0, s39, 20480
    s_mov_b32 s43, 442368
    buffer_load_dwordx4 v5, s[16:19], s43 offen lds
    s_waitcnt lgkmcnt(2)
    v_mfma_f32_32x32x16_bf16 v[80:95], v[64:67], v[24:27], v[80:95]
    ds_read_b128 v[44:47], v17
    ds_read_b64_tr_b16 v[72:73], v18 offset:12288
    ds_read_b64_tr_b16 v[74:75], v18 offset:13312
    s_add_u32 m0, s39, 24576
    s_add_u32 s42, s38, 896
    buffer_load_dwordx4 v4, s[12:15], s42 offen lds
    s_waitcnt lgkmcnt(3)
    v_mfma_f32_32x32x16_bf16 v[96:111], v[68:71], v[24:27], v[96:111]
    ds_read_b64_tr_b16 v[76:77], v23 offset:12288
    ds_read_b64_tr_b16 v[78:79], v23 offset:13312
    s_add_u32 m0, s39, 28672
    s_add_u32 s42, s38, 33664
    buffer_load_dwordx4 v4, s[12:15], s42 offen lds
    s_waitcnt lgkmcnt(0)
    s_waitcnt vmcnt(18)
    s_barrier
    v_add_u32 v14, 98304, v10
    v_add_u32 v15, 98304, v11
    v_add_u32 v16, 98304, v12
    v_add_u32 v17, 98304, v13
    v_add_u32 v18, 106496, v6
    v_xor_b32 v23, 64, v18
    v_mfma_f32_32x32x16_bf16 v[80:95], v[72:75], v[44:47], v[80:95]
    ds_read_b128 v[24:27], v14
    ds_read_b64_tr_b16 v[64:65], v18 offset:0
    ds_read_b64_tr_b16 v[66:67], v18 offset:1024
    s_add_u32 m0, s39, 32768
    s_mov_b32 s43, 458752
    buffer_load_dwordx4 v5, s[16:19], s43 offen lds
    v_mfma_f32_32x32x16_bf16 v[96:111], v[76:79], v[44:47], v[96:111]
    ds_read_b64_tr_b16 v[68:69], v23 offset:0
    ds_read_b64_tr_b16 v[70:71], v23 offset:1024
    s_add_u32 m0, s39, 36864
    s_mov_b32 s43, 475136
    buffer_load_dwordx4 v5, s[16:19], s43 offen lds
    s_waitcnt lgkmcnt(2)
    v_mfma_f32_32x32x16_bf16 v[80:95], v[64:67], v[24:27], v[80:95]
    ds_read_b128 v[44:47], v15
    ds_read_b64_tr_b16 v[72:73], v18 offset:4096
    ds_read_b64_tr_b16 v[74:75], v18 offset:5120
    s_add_u32 m0, s39, 40960
    s_mov_b32 s43, 491520
    buffer_load_dwordx4 v5, s[16:19], s43 offen lds
    s_waitcnt lgkmcnt(3)
    v_mfma_f32_32x32x16_bf16 v[96:111], v[68:71], v[24:27], v[96:111]
    ds_read_b64_tr_b16 v[76:77], v23 offset:4096
    ds_read_b64_tr_b16 v[78:79], v23 offset:5120
    s_add_u32 m0, s39, 45056
    s_mov_b32 s43, 507904
    buffer_load_dwordx4 v5, s[16:19], s43 offen lds
    s_waitcnt lgkmcnt(2)
    v_mfma_f32_32x32x16_bf16 v[80:95], v[72:75], v[44:47], v[80:95]
    ds_read_b128 v[24:27], v16
    ds_read_b64_tr_b16 v[64:65], v18 offset:8192
    ds_read_b64_tr_b16 v[66:67], v18 offset:9216
    s_waitcnt lgkmcnt(3)
    v_mfma_f32_32x32x16_bf16 v[96:111], v[76:79], v[44:47], v[96:111]
    ds_read_b64_tr_b16 v[68:69], v23 offset:8192
    ds_read_b64_tr_b16 v[70:71], v23 offset:9216
    s_waitcnt lgkmcnt(2)
    v_mfma_f32_32x32x16_bf16 v[80:95], v[64:67], v[24:27], v[80:95]
    ds_read_b128 v[44:47], v17
    ds_read_b64_tr_b16 v[72:73], v18 offset:12288
    ds_read_b64_tr_b16 v[74:75], v18 offset:13312
    s_waitcnt lgkmcnt(3)
    v_mfma_f32_32x32x16_bf16 v[96:111], v[68:71], v[24:27], v[96:111]
    ds_read_b64_tr_b16 v[76:77], v23 offset:12288
    ds_read_b64_tr_b16 v[78:79], v23 offset:13312
    s_waitcnt lgkmcnt(0)
    s_waitcnt vmcnt(12)
    s_barrier
    v_add_u32 v14, 122880, v10
    v_add_u32 v15, 122880, v11
    v_add_u32 v16, 122880, v12
    v_add_u32 v17, 122880, v13
    v_add_u32 v18, 131072, v6
    v_xor_b32 v23, 64, v18
    v_mfma_f32_32x32x16_bf16 v[80:95], v[72:75], v[44:47], v[80:95]
    ds_read_b128 v[24:27], v14
    ds_read_b64_tr_b16 v[64:65], v18 offset:0
    ds_read_b64_tr_b16 v[66:67], v18 offset:1024
    v_mfma_f32_32x32x16_bf16 v[96:111], v[76:79], v[44:47], v[96:111]
    ds_read_b64_tr_b16 v[68:69], v23 offset:0
    ds_read_b64_tr_b16 v[70:71], v23 offset:1024
    buffer_load_dword v21, v22, s[28:31], 0 offen sc1
    s_waitcnt lgkmcnt(2)
    v_mfma_f32_32x32x16_bf16 v[80:95], v[64:67], v[24:27], v[80:95]
    ds_read_b128 v[44:47], v15
    ds_read_b64_tr_b16 v[72:73], v18 offset:4096
    ds_read_b64_tr_b16 v[74:75], v18 offset:5120
    s_waitcnt lgkmcnt(3)
    v_mfma_f32_32x32x16_bf16 v[96:111], v[68:71], v[24:27], v[96:111]
    ds_read_b64_tr_b16 v[76:77], v23 offset:4096
    ds_read_b64_tr_b16 v[78:79], v23 offset:5120
    s_waitcnt lgkmcnt(2)
    v_mfma_f32_32x32x16_bf16 v[80:95], v[72:75], v[44:47], v[80:95]
    ds_read_b128 v[24:27], v16
    ds_read_b64_tr_b16 v[64:65], v18 offset:8192
    ds_read_b64_tr_b16 v[66:67], v18 offset:9216
    s_waitcnt lgkmcnt(3)
    v_mfma_f32_32x32x16_bf16 v[96:111], v[76:79], v[44:47], v[96:111]
    ds_read_b64_tr_b16 v[68:69], v23 offset:8192
    ds_read_b64_tr_b16 v[70:71], v23 offset:9216
    s_waitcnt lgkmcnt(2)
    v_mfma_f32_32x32x16_bf16 v[80:95], v[64:67], v[24:27], v[80:95]
    ds_read_b128 v[44:47], v17
    ds_read_b64_tr_b16 v[72:73], v18 offset:12288
    ds_read_b64_tr_b16 v[74:75], v18 offset:13312
    s_waitcnt lgkmcnt(3)
    v_mfma_f32_32x32x16_bf16 v[96:111], v[68:71], v[24:27], v[96:111]
    ds_read_b64_tr_b16 v[76:77], v23 offset:12288
    ds_read_b64_tr_b16 v[78:79], v23 offset:13312
    s_waitcnt lgkmcnt(0)
    s_waitcnt vmcnt(7)
    s_barrier
    v_add_u32 v14, 0, v10
    v_add_u32 v15, 0, v11
    v_add_u32 v16, 0, v12
    v_add_u32 v17, 0, v13
    v_add_u32 v18, 8192, v6
    v_xor_b32 v23, 64, v18
    v_mfma_f32_32x32x16_bf16 v[80:95], v[72:75], v[44:47], v[80:95]
    ds_read_b128 v[24:27], v14
    ds_read_b64_tr_b16 v[64:65], v18 offset:0
    ds_read_b64_tr_b16 v[66:67], v18 offset:1024
    v_mfma_f32_32x32x16_bf16 v[96:111], v[76:79], v[44:47], v[96:111]
    ds_read_b64_tr_b16 v[68:69], v23 offset:0
    ds_read_b64_tr_b16 v[70:71], v23 offset:1024
    v_xor_b32 v3, 0, v220
    ds_read_b64 v[160:161], v3
    v_xor_b32 v3, 16, v220
    ds_read_b64 v[162:163], v3
    v_xor_b32 v3, 32, v220
    ds_read_b64 v[164:165], v3
    v_xor_b32 v3, 48, v220
    ds_read_b64 v[166:167], v3
    v_xor_b32 v3, 64, v220
    ds_read_b64 v[168:169], v3
    v_xor_b32 v3, 80, v220
    ds_read_b64 v[170:171], v3
    v_xor_b32 v3, 96, v220
    ds_read_b64 v[172:173], v3
    v_xor_b32 v3, 112, v220
    ds_read_b64 v[174:175], v3
    s_waitcnt lgkmcnt(10)
    v_mfma_f32_32x32x16_bf16 v[80:95], v[64:67], v[24:27], v[80:95]
    ds_read_b128 v[44:47], v15
    ds_read_b64_tr_b16 v[72:73], v18 offset:4096
    ds_read_b64_tr_b16 v[74:75], v18 offset:5120
    s_waitcnt lgkmcnt(11)
    v_mfma_f32_32x32x16_bf16 v[96:111], v[68:71], v[24:27], v[96:111]
    ds_read_b64_tr_b16 v[76:77], v23 offset:4096
    ds_read_b64_tr_b16 v[78:79], v23 offset:5120
    s_waitcnt lgkmcnt(2)
    v_mfma_f32_32x32x16_bf16 v[80:95], v[72:75], v[44:47], v[80:95]
    ds_read_b128 v[24:27], v16
    ds_read_b64_tr_b16 v[64:65], v18 offset:8192
    ds_read_b64_tr_b16 v[66:67], v18 offset:9216
    s_waitcnt lgkmcnt(3)
    v_mfma_f32_32x32x16_bf16 v[96:111], v[76:79], v[44:47], v[96:111]
    ds_read_b64_tr_b16 v[68:69], v23 offset:8192
    ds_read_b64_tr_b16 v[70:71], v23 offset:9216
    s_waitcnt lgkmcnt(2)
    v_mfma_f32_32x32x16_bf16 v[80:95], v[64:67], v[24:27], v[80:95]
    ds_read_b128 v[44:47], v17
    ds_read_b64_tr_b16 v[72:73], v18 offset:12288
    ds_read_b64_tr_b16 v[74:75], v18 offset:13312
    s_waitcnt lgkmcnt(3)
    v_mfma_f32_32x32x16_bf16 v[96:111], v[68:71], v[24:27], v[96:111]
    ds_read_b64_tr_b16 v[76:77], v23 offset:12288
    ds_read_b64_tr_b16 v[78:79], v23 offset:13312
    s_waitcnt lgkmcnt(0)
    s_waitcnt vmcnt(1)
    s_barrier
    v_add_u32 v14, 24576, v10
    v_add_u32 v15, 24576, v11
    v_add_u32 v16, 24576, v12
    v_add_u32 v17, 24576, v13
    v_add_u32 v18, 32768, v6
    v_xor_b32 v23, 64, v18
    v_mfma_f32_32x32x16_bf16 v[80:95], v[72:75], v[44:47], v[80:95]
    ds_read_b128 v[24:27], v14
    ds_read_b64_tr_b16 v[64:65], v18 offset:0
    ds_read_b64_tr_b16 v[66:67], v18 offset:1024
    v_mfma_f32_32x32x16_bf16 v[96:111], v[76:79], v[44:47], v[96:111]
    ds_read_b64_tr_b16 v[68:69], v23 offset:0
    ds_read_b64_tr_b16 v[70:71], v23 offset:1024
    v_lshlrev_b32 v112, 16, v160
    v_and_b32 v113, 0xffff0000, v160
    v_lshlrev_b32 v114, 16, v161
    v_and_b32 v115, 0xffff0000, v161
    v_lshlrev_b32 v116, 16, v162
    v_and_b32 v117, 0xffff0000, v162
    v_lshlrev_b32 v118, 16, v163
    v_and_b32 v119, 0xffff0000, v163
    v_lshlrev_b32 v120, 16, v164
    v_and_b32 v121, 0xffff0000, v164
    v_lshlrev_b32 v122, 16, v165
    v_and_b32 v123, 0xffff0000, v165
    v_lshlrev_b32 v124, 16, v166
    v_and_b32 v125, 0xffff0000, v166
    v_lshlrev_b32 v126, 16, v167
    v_and_b32 v127, 0xffff0000, v167
    v_lshlrev_b32 v128, 16, v168
    v_and_b32 v129, 0xffff0000, v168
    v_lshlrev_b32 v130, 16, v169
    v_and_b32 v131, 0xffff0000, v169
    v_lshlrev_b32 v132, 16, v170
    v_and_b32 v133, 0xffff0000, v170
    v_lshlrev_b32 v134, 16, v171
    v_and_b32 v135, 0xffff0000, v171
    v_lshlrev_b32 v136, 16, v172
    v_and_b32 v137, 0xffff0000, v172
    v_lshlrev_b32 v138, 16, v173
    v_and_b32 v139, 0xffff0000, v173
    v_lshlrev_b32 v140, 16, v174
    v_and_b32 v141, 0xffff0000, v174
    v_lshlrev_b32 v142, 16, v175
    v_and_b32 v143, 0xffff0000, v175
    s_waitcnt lgkmcnt(2)
    v_mfma_f32_32x32x16_bf16 v[80:95], v[64:67], v[24:27], v[80:95]
    ds_read_b128 v[44:47], v15
    ds_read_b64_tr_b16 v[72:73], v18 offset:4096
    ds_read_b64_tr_b16 v[74:75], v18 offset:5120
    s_waitcnt lgkmcnt(3)
    v_mfma_f32_32x32x16_bf16 v[96:111], v[68:71], v[24:27], v[96:111]
    ds_read_b64_tr_b16 v[76:77], v23 offset:4096
    ds_read_b64_tr_b16 v[78:79], v23 offset:5120
    s_waitcnt lgkmcnt(2)
    v_mfma_f32_32x32x16_bf16 v[80:95], v[72:75], v[44:47], v[80:95]
    ds_read_b128 v[24:27], v16
    ds_read_b64_tr_b16 v[64:65], v18 offset:8192
    ds_read_b64_tr_b16 v[66:67], v18 offset:9216
    s_waitcnt lgkmcnt(3)
    v_mfma_f32_32x32x16_bf16 v[96:111], v[76:79], v[44:47], v[96:111]
    ds_read_b64_tr_b16 v[68:69], v23 offset:8192
    ds_read_b64_tr_b16 v[70:71], v23 offset:9216
    s_waitcnt lgkmcnt(2)
    v_mfma_f32_32x32x16_bf16 v[80:95], v[64:67], v[24:27], v[80:95]
    ds_read_b128 v[44:47], v17
    ds_read_b64_tr_b16 v[72:73], v18 offset:12288
    ds_read_b64_tr_b16 v[74:75], v18 offset:13312
    s_waitcnt lgkmcnt(3)
    v_mfma_f32_32x32x16_bf16 v[96:111], v[68:71], v[24:27], v[96:111]
    ds_read_b64_tr_b16 v[76:77], v23 offset:12288
    ds_read_b64_tr_b16 v[78:79], v23 offset:13312
    s_waitcnt lgkmcnt(2)
    v_mfma_f32_32x32x16_bf16 v[80:95], v[72:75], v[44:47], v[80:95]
    s_waitcnt lgkmcnt(0)
    v_mfma_f32_32x32x16_bf16 v[96:111], v[76:79], v[44:47], v[96:111]
    s_waitcnt vmcnt(0)
    s_mov_b32 s37, 0
fused_kernel_ncpollG:
    v_readfirstlane_b32 s3, v21
    s_add_u32 s37, s37, 1
    s_cmp_gt_u32 s37, 100000
    s_cbranch_scc1 fused_kernel_ncokG
    s_cmp_lg_u32 s3, 0
    s_cbranch_scc1 fused_kernel_ncokG
    buffer_load_dword v21, v22, s[28:31], 0 offen sc1
    s_waitcnt vmcnt(0)
    s_branch fused_kernel_ncpollG
fused_kernel_ncokG:
    s_nop 7
    v_pk_add_f32 v[80:81], v[80:81], v[112:113]
    v_pk_add_f32 v[82:83], v[82:83], v[114:115]
    v_pk_add_f32 v[84:85], v[84:85], v[116:117]
    v_pk_add_f32 v[86:87], v[86:87], v[118:119]
    v_pk_add_f32 v[88:89], v[88:89], v[120:121]
    v_pk_add_f32 v[90:91], v[90:91], v[122:123]
    v_pk_add_f32 v[92:93], v[92:93], v[124:125]
    v_pk_add_f32 v[94:95], v[94:95], v[126:127]
    v_pk_add_f32 v[96:97], v[96:97], v[128:129]
    v_pk_add_f32 v[98:99], v[98:99], v[130:131]
    v_pk_add_f32 v[100:101], v[100:101], v[132:133]
    v_pk_add_f32 v[102:103], v[102:103], v[134:135]
    v_pk_add_f32 v[104:105], v[104:105], v[136:137]
    v_pk_add_f32 v[106:107], v[106:107], v[138:139]
    v_pk_add_f32 v[108:109], v[108:109], v[140:141]
    v_pk_add_f32 v[110:111], v[110:111], v[142:143]
    v_pk_add_f32 v[180:181], v[80:81], v[82:83]
    v_pk_mul_f32 v[182:183], v[80:81], v[80:81]
    v_pk_fma_f32 v[182:183], v[82:83], v[82:83], v[182:183]
    v_pk_add_f32 v[180:181], v[180:181], v[84:85]
    v_pk_fma_f32 v[182:183], v[84:85], v[84:85], v[182:183]
    v_pk_add_f32 v[180:181], v[180:181], v[86:87]
    v_pk_fma_f32 v[182:183], v[86:87], v[86:87], v[182:183]
    v_pk_add_f32 v[180:181], v[180:181], v[88:89]
    v_pk_fma_f32 v[182:183], v[88:89], v[88:89], v[182:183]
    v_pk_add_f32 v[180:181], v[180:181], v[90:91]
    v_pk_fma_f32 v[182:183], v[90:91], v[90:91], v[182:183]
    v_pk_add_f32 v[180:181], v[180:181], v[92:93]
    v_pk_fma_f32 v[182:183], v[92:93], v[92:93], v[182:183]
    v_pk_add_f32 v[180:181], v[180:181], v[94:95]
    v_pk_fma_f32 v[182:183], v[94:95], v[94:95], v[182:183]
    v_pk_add_f32 v[180:181], v[180:181], v[96:97]
    v_pk_fma_f32 v[182:183], v[96:97], v[96:97], v[182:183]
    v_pk_add_f32 v[180:181], v[180:181], v[98:99]
    v_pk_fma_f32 v[182:183], v[98:99], v[98:99], v[182:183]
    v_pk_add_f32 v[180:181], v[180:181], v[100:101]
    v_pk_fma_f32 v[182:183], v[100:101], v[100:101], v[182:183]
    v_pk_add_f32 v[180:181], v[180:181], v[102:103]
    v_pk_fma_f32 v[182:183], v[102:103], v[102:103], v[182:183]
    v_pk_add_f32 v[180:181], v[180:181], v[104:105]
    v_pk_fma_f32 v[182:183], v[104:105], v[104:105], v[182:183]
    v_pk_add_f32 v[180:181], v[180:181], v[106:107]
    v_pk_fma_f32 v[182:183], v[106:107], v[106:107], v[182:183]
    v_pk_add_f32 v[180:181], v[180:181], v[108:109]
    v_pk_fma_f32 v[182:183], v[108:109], v[108:109], v[182:183]
    v_pk_add_f32 v[180:181], v[180:181], v[110:111]
    v_pk_fma_f32 v[182:183], v[110:111], v[110:111], v[182:183]
    v_add_f32 v176, v180, v181
    v_add_f32 v178, v182, v183
    v_mov_b32 v2, v176
    v_mov_b32 v3, v178
    v_mov_b32 v177, v21
    v_mov_b32 v179, v21
    v_permlane32_swap_b32 v176, v2
    v_permlane32_swap_b32 v178, v3
    v_add_f32 v176, v176, v2
    v_add_f32 v178, v178, v3
    s_mov_b64 exec, 0xffffffff
    buffer_store_dwordx4 v[176:179], v222, s[20:23], s93 offen sc1
    s_mov_b64 exec, -1
    v_cvt_pk_bf16_f32 v160, v80, v81
    v_cvt_pk_bf16_f32 v161, v82, v83
    v_cvt_pk_bf16_f32 v162, v84, v85
    v_cvt_pk_bf16_f32 v163, v86, v87
    v_cvt_pk_bf16_f32 v164, v88, v89
    v_cvt_pk_bf16_f32 v165, v90, v91
    v_cvt_pk_bf16_f32 v166, v92, v93
    v_cvt_pk_bf16_f32 v167, v94, v95
    v_cvt_pk_bf16_f32 v168, v96, v97
    v_cvt_pk_bf16_f32 v169, v98, v99
    v_cvt_pk_bf16_f32 v170, v100, v101
    v_cvt_pk_bf16_f32 v171, v102, v103
    v_cvt_pk_bf16_f32 v172, v104, v105
    v_cvt_pk_bf16_f32 v173, v106, v107
    v_cvt_pk_bf16_f32 v174, v108, v109
    v_cvt_pk_bf16_f32 v175, v110, v111
    s_nop 1
    v_permlane32_swap_b32 v160, v162
    v_permlane32_swap_b32 v161, v163
    v_permlane32_swap_b32 v164, v166
    v_permlane32_swap_b32 v165, v167
    v_permlane32_swap_b32 v168, v170
    v_permlane32_swap_b32 v169, v171
    v_permlane32_swap_b32 v172, v174
    v_permlane32_swap_b32 v173, v175
    s_mov_b32 s37, 0
    buffer_load_dwordx4 v[184:187], v221, s[20:23], 0 offen offset:0 sc1
    buffer_load_dwordx4 v[188:191], v221, s[20:23], 0 offen offset:512 sc1
    buffer_load_dwordx4 v[192:195], v221, s[20:23], 0 offen offset:1024 sc1
    buffer_load_dwordx4 v[196:199], v221, s[20:23], 0 offen offset:1536 sc1
fused_kernel_poll:
    s_add_u32 s37, s37, 1
    s_cmp_gt_u32 s37, 100000
    s_cbranch_scc1 fused_kernel_pollx
    s_sleep 4
    buffer_load_dwordx4 v[200:203], v221, s[20:23], 0 offen offset:0 sc1
    buffer_load_dwordx4 v[204:207], v221, s[20:23], 0 offen offset:512 sc1
    buffer_load_dwordx4 v[208:211], v221, s[20:23], 0 offen offset:1024 sc1
    buffer_load_dwordx4 v[212:215], v221, s[20:23], 0 offen offset:1536 sc1
    s_waitcnt vmcnt(4)
    v_xor_b32 v2, v185, v21
    v_xor_b32 v3, v187, v21
    v_or_b32 v2, v2, v3
    v_xor_b32 v3, v189, v21
    v_or_b32 v2, v2, v3
    v_xor_b32 v3, v191, v21
    v_or_b32 v2, v2, v3
    v_xor_b32 v3, v193, v21
    v_or_b32 v2, v2, v3
    v_xor_b32 v3, v195, v21
    v_or_b32 v2, v2, v3
    v_xor_b32 v3, v197, v21
    v_or_b32 v2, v2, v3
    v_xor_b32 v3, v199, v21
    v_or_b32 v2, v2, v3
    v_cmp_ne_u32 vcc, 0, v2
    s_nop 4
    s_cbranch_vccz fused_kernel_pollx
    buffer_load_dwordx4 v[184:187], v221, s[20:23], 0 offen offset:0 sc1
    buffer_load_dwordx4 v[188:191], v221, s[20:23], 0 offen offset:512 sc1
    buffer_load_dwordx4 v[192:195], v221, s[20:23], 0 offen offset:1024 sc1
    buffer_load_dwordx4 v[196:199], v221, s[20:23], 0 offen offset:1536 sc1
    s_waitcnt vmcnt(4)
    v_xor_b32 v2, v201, v21
    v_xor_b32 v3, v203, v21
    v_or_b32 v2, v2, v3
    v_xor_b32 v3, v205, v21
    v_or_b32 v2, v2, v3
    v_xor_b32 v3, v207, v21
    v_or_b32 v2, v2, v3
    v_xor_b32 v3, v209, v21
    v_or_b32 v2, v2, v3
    v_xor_b32 v3, v211, v21
    v_or_b32 v2, v2, v3
    v_xor_b32 v3, v213, v21
    v_or_b32 v2, v2, v3
    v_xor_b32 v3, v215, v21
    v_or_b32 v2, v2, v3
    v_cmp_ne_u32 vcc, 0, v2
    s_nop 4
    s_cbranch_vccnz fused_kernel_poll
    s_waitcnt vmcnt(0)
fused_kernel_pollx:
    s_mov_b32 s36, 2097152
    v_add_f32 v184, v184, v188
    v_add_f32 v186, v186, v190
    v_add_f32 v184, v184, v192
    v_add_f32 v186, v186, v194
    v_add_f32 v184, v184, v196
    v_add_f32 v186, v186, v198
    v_mov_b32 v2, v184
    v_mov_b32 v3, v186
    buffer_store_dwordx4 v[160:163], v19, s[20:23], s36 offen offset:0 sc1
    buffer_store_dwordx4 v[164:167], v19, s[20:23], s36 offen offset:1024 sc1
    buffer_store_dwordx4 v[168:171], v19, s[20:23], s36 offen offset:2048 sc1
    buffer_store_dwordx4 v[172:175], v19, s[20:23], s36 offen offset:3072 sc1
    v_permlane32_swap_b32 v184, v2
    v_permlane32_swap_b32 v186, v3
    v_add_f32 v184, v184, v2
    v_add_f32 v186, v186, v3
    v_mul_f32 v184, 0x3b000000, v184
    v_mul_f32 v186, 0x3b000000, v186
    v_fma_f32 v186, -v184, v184, v186
    v_max_f32 v186, 0, v186
    v_add_f32 v186, 0x3727c5ac, v186
    v_rsq_f32 v188, v186
    s_nop 0
    v_mul_f32 v190, v184, v188
    v_sub_f32 v190, 0, v190
    v_mul_f32 v192, 0xbfb8aa3b, v188
    v_mul_f32 v194, 0xbfb8aa3b, v190
    v_pk_fma_f32 v[24:25], v[80:81], v[192:193], v[194:195] op_sel_hi:[1,0,0]
    v_pk_fma_f32 v[26:27], v[82:83], v[192:193], v[194:195] op_sel_hi:[1,0,0]
    v_pk_fma_f32 v[28:29], v[84:85], v[192:193], v[194:195] op_sel_hi:[1,0,0]
    v_pk_fma_f32 v[30:31], v[86:87], v[192:193], v[194:195] op_sel_hi:[1,0,0]
    v_exp_f32 v24, v24
    v_exp_f32 v25, v25
    v_exp_f32 v26, v26
    v_exp_f32 v27, v27
    v_exp_f32 v28, v28
    v_exp_f32 v29, v29
    v_exp_f32 v30, v30
    v_exp_f32 v31, v31
    v_pk_fma_f32 v[80:81], v[80:81], v[188:189], v[190:191] op_sel_hi:[1,0,0]
    v_pk_fma_f32 v[82:83], v[82:83], v[188:189], v[190:191] op_sel_hi:[1,0,0]
    v_pk_fma_f32 v[84:85], v[84:85], v[188:189], v[190:191] op_sel_hi:[1,0,0]
    v_pk_fma_f32 v[86:87], v[86:87], v[188:189], v[190:191] op_sel_hi:[1,0,0]
    v_pk_add_f32 v[24:25], v[24:25], 1.0 op_sel_hi:[1,0]
    v_pk_add_f32 v[26:27], v[26:27], 1.0 op_sel_hi:[1,0]
    v_pk_add_f32 v[28:29], v[28:29], 1.0 op_sel_hi:[1,0]
    v_pk_add_f32 v[30:31], v[30:31], 1.0 op_sel_hi:[1,0]
    v_rcp_f32 v24, v24
    v_rcp_f32 v25, v25
    v_rcp_f32 v26, v26
    v_rcp_f32 v27, v27
    v_rcp_f32 v28, v28
    v_rcp_f32 v29, v29
    v_rcp_f32 v30, v30
    v_rcp_f32 v31, v31
    s_nop 0
    v_pk_mul_f32 v[80:81], v[80:81], v[24:25]
    v_pk_mul_f32 v[82:83], v[82:83], v[26:27]
    v_pk_mul_f32 v[84:85], v[84:85], v[28:29]
    v_pk_mul_f32 v[86:87], v[86:87], v[30:31]
    v_cvt_pk_bf16_f32 v64, v80, v81
    v_cvt_pk_bf16_f32 v65, v82, v83
    v_cvt_pk_bf16_f32 v66, v84, v85
    v_cvt_pk_bf16_f32 v67, v86, v87
    buffer_store_dwordx4 v[64:67], v19, s[20:23], 0 offen offset:0 sc1
    v_pk_fma_f32 v[32:33], v[88:89], v[192:193], v[194:195] op_sel_hi:[1,0,0]
    v_pk_fma_f32 v[34:35], v[90:91], v[192:193], v[194:195] op_sel_hi:[1,0,0]
    v_pk_fma_f32 v[36:37], v[92:93], v[192:193], v[194:195] op_sel_hi:[1,0,0]
    v_pk_fma_f32 v[38:39], v[94:95], v[192:193], v[194:195] op_sel_hi:[1,0,0]
    v_exp_f32 v32, v32
    v_exp_f32 v33, v33
    v_exp_f32 v34, v34
    v_exp_f32 v35, v35
    v_exp_f32 v36, v36
    v_exp_f32 v37, v37
    v_exp_f32 v38, v38
    v_exp_f32 v39, v39
    v_pk_fma_f32 v[88:89], v[88:89], v[188:189], v[190:191] op_sel_hi:[1,0,0]
    v_pk_fma_f32 v[90:91], v[90:91], v[188:189], v[190:191] op_sel_hi:[1,0,0]
    v_pk_fma_f32 v[92:93], v[92:93], v[188:189], v[190:191] op_sel_hi:[1,0,0]
    v_pk_fma_f32 v[94:95], v[94:95], v[188:189], v[190:191] op_sel_hi:[1,0,0]
    v_pk_add_f32 v[32:33], v[32:33], 1.0 op_sel_hi:[1,0]
    v_pk_add_f32 v[34:35], v[34:35], 1.0 op_sel_hi:[1,0]
    v_pk_add_f32 v[36:37], v[36:37], 1.0 op_sel_hi:[1,0]
    v_pk_add_f32 v[38:39], v[38:39], 1.0 op_sel_hi:[1,0]
    v_rcp_f32 v32, v32
    v_rcp_f32 v33, v33
    v_rcp_f32 v34, v34
    v_rcp_f32 v35, v35
    v_rcp_f32 v36, v36
    v_rcp_f32 v37, v37
    v_rcp_f32 v38, v38
    v_rcp_f32 v39, v39
    s_nop 0
    v_pk_mul_f32 v[88:89], v[88:89], v[32:33]
    v_pk_mul_f32 v[90:91], v[90:91], v[34:35]
    v_pk_mul_f32 v[92:93], v[92:93], v[36:37]
    v_pk_mul_f32 v[94:95], v[94:95], v[38:39]
    v_cvt_pk_bf16_f32 v68, v88, v89
    v_cvt_pk_bf16_f32 v69, v90, v91
    v_cvt_pk_bf16_f32 v70, v92, v93
    v_cvt_pk_bf16_f32 v71, v94, v95
    buffer_store_dwordx4 v[68:71], v19, s[20:23], 0 offen offset:1024 sc1
    v_pk_fma_f32 v[24:25], v[96:97], v[192:193], v[194:195] op_sel_hi:[1,0,0]
    v_pk_fma_f32 v[26:27], v[98:99], v[192:193], v[194:195] op_sel_hi:[1,0,0]
    v_pk_fma_f32 v[28:29], v[100:101], v[192:193], v[194:195] op_sel_hi:[1,0,0]
    v_pk_fma_f32 v[30:31], v[102:103], v[192:193], v[194:195] op_sel_hi:[1,0,0]
    v_exp_f32 v24, v24
    v_exp_f32 v25, v25
    v_exp_f32 v26, v26
    v_exp_f32 v27, v27
    v_exp_f32 v28, v28
    v_exp_f32 v29, v29
    v_exp_f32 v30, v30
    v_exp_f32 v31, v31
    v_pk_fma_f32 v[96:97], v[96:97], v[188:189], v[190:191] op_sel_hi:[1,0,0]
    v_pk_fma_f32 v[98:99], v[98:99], v[188:189], v[190:191] op_sel_hi:[1,0,0]
    v_pk_fma_f32 v[100:101], v[100:101], v[188:189], v[190:191] op_sel_hi:[1,0,0]
    v_pk_fma_f32 v[102:103], v[102:103], v[188:189], v[190:191] op_sel_hi:[1,0,0]
    v_pk_add_f32 v[24:25], v[24:25], 1.0 op_sel_hi:[1,0]
    v_pk_add_f32 v[26:27], v[26:27], 1.0 op_sel_hi:[1,0]
    v_pk_add_f32 v[28:29], v[28:29], 1.0 op_sel_hi:[1,0]
    v_pk_add_f32 v[30:31], v[30:31], 1.0 op_sel_hi:[1,0]
    v_rcp_f32 v24, v24
    v_rcp_f32 v25, v25
    v_rcp_f32 v26, v26
    v_rcp_f32 v27, v27
    v_rcp_f32 v28, v28
    v_rcp_f32 v29, v29
    v_rcp_f32 v30, v30
    v_rcp_f32 v31, v31
    s_nop 0
    v_pk_mul_f32 v[96:97], v[96:97], v[24:25]
    v_pk_mul_f32 v[98:99], v[98:99], v[26:27]
    v_pk_mul_f32 v[100:101], v[100:101], v[28:29]
    v_pk_mul_f32 v[102:103], v[102:103], v[30:31]
    v_cvt_pk_bf16_f32 v72, v96, v97
    v_cvt_pk_bf16_f32 v73, v98, v99
    v_cvt_pk_bf16_f32 v74, v100, v101
    v_cvt_pk_bf16_f32 v75, v102, v103
    buffer_store_dwordx4 v[72:75], v19, s[20:23], 0 offen offset:2048 sc1
    v_pk_fma_f32 v[32:33], v[104:105], v[192:193], v[194:195] op_sel_hi:[1,0,0]
    v_pk_fma_f32 v[34:35], v[106:107], v[192:193], v[194:195] op_sel_hi:[1,0,0]
    v_pk_fma_f32 v[36:37], v[108:109], v[192:193], v[194:195] op_sel_hi:[1,0,0]
    v_pk_fma_f32 v[38:39], v[110:111], v[192:193], v[194:195] op_sel_hi:[1,0,0]
    v_exp_f32 v32, v32
    v_exp_f32 v33, v33
    v_exp_f32 v34, v34
    v_exp_f32 v35, v35
    v_exp_f32 v36, v36
    v_exp_f32 v37, v37
    v_exp_f32 v38, v38
    v_exp_f32 v39, v39
    v_pk_fma_f32 v[104:105], v[104:105], v[188:189], v[190:191] op_sel_hi:[1,0,0]
    v_pk_fma_f32 v[106:107], v[106:107], v[188:189], v[190:191] op_sel_hi:[1,0,0]
    v_pk_fma_f32 v[108:109], v[108:109], v[188:189], v[190:191] op_sel_hi:[1,0,0]
    v_pk_fma_f32 v[110:111], v[110:111], v[188:189], v[190:191] op_sel_hi:[1,0,0]
    v_pk_add_f32 v[32:33], v[32:33], 1.0 op_sel_hi:[1,0]
    v_pk_add_f32 v[34:35], v[34:35], 1.0 op_sel_hi:[1,0]
    v_pk_add_f32 v[36:37], v[36:37], 1.0 op_sel_hi:[1,0]
    v_pk_add_f32 v[38:39], v[38:39], 1.0 op_sel_hi:[1,0]
    v_rcp_f32 v32, v32
    v_rcp_f32 v33, v33
    v_rcp_f32 v34, v34
    v_rcp_f32 v35, v35
    v_rcp_f32 v36, v36
    v_rcp_f32 v37, v37
    v_rcp_f32 v38, v38
    v_rcp_f32 v39, v39
    s_nop 0
    v_pk_mul_f32 v[104:105], v[104:105], v[32:33]
    v_pk_mul_f32 v[106:107], v[106:107], v[34:35]
    v_pk_mul_f32 v[108:109], v[108:109], v[36:37]
    v_pk_mul_f32 v[110:111], v[110:111], v[38:39]
    v_cvt_pk_bf16_f32 v76, v104, v105
    v_cvt_pk_bf16_f32 v77, v106, v107
    v_cvt_pk_bf16_f32 v78, v108, v109
    v_cvt_pk_bf16_f32 v79, v110, v111
    buffer_store_dwordx4 v[76:79], v19, s[20:23], 0 offen offset:3072 sc1
    s_lshr_b32 s35, s34, 1
    s_and_b32 s36, s34, 1
    s_lshl_b32 s37, s36, 1
    s_add_u32 s37, s37, s35
    s_sub_u32 s37, s37, 1
    s_add_u32 s42, s36, 1
    s_lshl_b32 s42, s42, 2
    s_add_u32 s42, s42, s33
    s_and_b32 s92, s42, 7
    s_lshl_b32 s92, s92, 7
    s_lshr_b32 s42, s42, 3
    s_lshl_b32 s42, s42, 2
    s_add_u32 s42, s42, s92
    s_mul_i32 s93, s35, 16384
    s_add_u32 s42, s42, s93
    s_cmp_eq_u32 s36, 0
    s_cselect_b32 s43, 12, 0
    s_add_u32 s43, s43, s33
    s_and_b32 s92, s43, 7
    s_lshl_b32 s92, s92, 7
    s_lshr_b32 s43, s43, 3
    s_lshl_b32 s43, s43, 2
    s_add_u32 s43, s43, s92
    s_mul_i32 s93, s37, 16384
    s_add_u32 s43, s43, s93
    s_lshr_b32 s37, s37, 3
    s_lshr_b32 s35, s35, 3
    s_cmp_eq_u32 s37, s35
    s_cselect_b32 s92, -1, 0xffff
    s_mov_b32 s93, 0
    v_and_b32 v2, 15, v1
    v_mul_u32_u24 v2, 1024, v2
    v_mov_b32 v3, s43
    v_mov_b32 v7, s42
    v_cmp_gt_u32 vcc, 16, v1
    s_nop 1
    v_cndmask_b32 v3, v3, v7, vcc
    v_add_u32 v2, v2, v3
    s_mov_b32 s35, 11534336
    s_waitcnt vmcnt(0)
    s_barrier
    s_cmp_lg_u32 s32, 0
    s_cbranch_scc1 fused_kernel_ph2
    s_mov_b64 exec, s[92:93]
    buffer_store_dword v21, v2, s[20:23], s35 offen sc1
    s_mov_b64 exec, -1
    s_branch fused_kernel_ph2
fused_kernel_P:
    s_and_b32 s94, s34, 1
    s_lshr_b32 s36, s34, 1
    s_mul_i32 s38, s36, 288
    s_mul_i32 s37, s94, 160
    s_add_u32 s38, s38, s37
    s_lshr_b32 s95, s36, 1
    s_lshl_b32 s95, s95, 16
    s_lshl_b32 s93, s38, 10
    s_lshr_b32 s92, s95, 9
    s_waitcnt lgkmcnt(0)
    s_mov_b32 s12, s44
    s_and_b32 s13, s45, 0xffff
    s_mov_b32 s14, 0x480000
    s_mov_b32 s15, 0x00020000
    s_mov_b32 s16, s10
    s_and_b32 s17, s11, 0xffff
    s_mov_b32 s18, 0x80000
    s_mov_b32 s19, 0x00020000
    s_add_u32 s37, s92, 0
    s_and_b32 s37, s37, 0x3ff
    s_add_u32 s91, s37, s93
    s_lshl_b32 s90, s37, 9
    s_add_u32 m0, s39, 0
    s_add_u32 s43, s90, 0
    buffer_load_dwordx4 v5, s[16:19], s43 offen lds
    s_add_u32 m0, s39, 4096
    s_add_u32 s43, s90, 16384
    buffer_load_dwordx4 v5, s[16:19], s43 offen lds
    s_add_u32 m0, s39, 8192
    s_add_u32 s43, s90, 32768
    buffer_load_dwordx4 v5, s[16:19], s43 offen lds
    s_add_u32 m0, s39, 12288
    s_add_u32 s43, s90, 49152
    buffer_load_dwordx4 v5, s[16:19], s43 offen lds
    s_add_u32 m0, s39, 16384
    s_add_u32 s42, s91, 0
    buffer_load_dwordx4 v4, s[12:15], s42 offen lds
    s_add_u32 m0, s39, 20480
    s_add_u32 s42, s91, 32768
    buffer_load_dwordx4 v4, s[12:15], s42 offen lds
    s_add_u32 m0, s39, 24576
    s_add_u32 s42, s91, 65536
    buffer_load_dwordx4 v4, s[12:15], s42 offen lds
    s_add_u32 s37, s92, 128
    s_and_b32 s37, s37, 0x3ff
    s_add_u32 s91, s37, s93
    s_lshl_b32 s90, s37, 9
    s_add_u32 m0, s39, 28672
    s_add_u32 s43, s90, 0
    buffer_load_dwordx4 v5, s[16:19], s43 offen lds
    s_add_u32 m0, s39, 32768
    s_add_u32 s43, s90, 16384
    buffer_load_dwordx4 v5, s[16:19], s43 offen lds
    s_add_u32 m0, s39, 36864
    s_add_u32 s43, s90, 32768
    buffer_load_dwordx4 v5, s[16:19], s43 offen lds
    s_add_u32 m0, s39, 40960
    s_add_u32 s43, s90, 49152
    buffer_load_dwordx4 v5, s[16:19], s43 offen lds
    s_add_u32 m0, s39, 45056
    s_add_u32 s42, s91, 0
    buffer_load_dwordx4 v4, s[12:15], s42 offen lds
    s_add_u32 m0, s39, 49152
    s_add_u32 s42, s91, 32768
    buffer_load_dwordx4 v4, s[12:15], s42 offen lds
    s_add_u32 m0, s39, 53248
    s_add_u32 s42, s91, 65536
    buffer_load_dwordx4 v4, s[12:15], s42 offen lds
    s_add_u32 s37, s92, 256
    s_and_b32 s37, s37, 0x3ff
    s_add_u32 s91, s37, s93
    s_lshl_b32 s90, s37, 9
    s_add_u32 m0, s39, 57344
    s_add_u32 s43, s90, 0
    buffer_load_dwordx4 v5, s[16:19], s43 offen lds
    s_add_u32 m0, s39, 61440
    s_add_u32 s43, s90, 16384
    buffer_load_dwordx4 v5, s[16:19], s43 offen lds
    s_add_u32 m0, s39, 65536
    s_add_u32 s43, s90, 32768
    buffer_load_dwordx4 v5, s[16:19], s43 offen lds
    s_add_u32 m0, s39, 69632
    s_add_u32 s43, s90, 49152
    buffer_load_dwordx4 v5, s[16:19], s43 offen lds
    s_add_u32 m0, s39, 73728
    s_add_u32 s42, s91, 0
    buffer_load_dwordx4 v4, s[12:15], s42 offen lds
    s_add_u32 m0, s39, 77824
    s_add_u32 s42, s91, 32768
    buffer_load_dwordx4 v4, s[12:15], s42 offen lds
    s_add_u32 m0, s39, 81920
    s_add_u32 s42, s91, 65536
    buffer_load_dwordx4 v4, s[12:15], s42 offen lds
    s_mov_b32 s28, s48
    s_and_b32 s29, s49, 0xffff
    s_mov_b32 s30, 0x100
    s_mov_b32 s31, 0x00020000
    v_and_b32 v7, 31, v1
    v_lshrrev_b32 v8, 5, v1
    v_lshlrev_b32 v9, 4, v1
    v_lshrrev_b32 v2, 1, v7
    v_and_b32 v2, 7, v2
    v_xor_b32 v2, v2, v8
    v_lshlrev_b32 v2, 4, v2
    v_lshl_add_u32 v10, v7, 7, v2
    v_xor_b32 v11, 32, v10
    v_xor_b32 v12, 64, v10
    v_xor_b32 v13, 96, v10
    v_bfe_u32 v2, v1, 2, 2
    v_lshl_add_u32 v3, v8, 3, v2
    v_lshlrev_b32 v6, 8, v3
    v_xor_b32 v2, s32, v2
    v_lshl_add_u32 v6, v2, 6, v6
    v_bfe_u32 v2, v1, 4, 1
    v_lshl_add_u32 v6, v2, 5, v6
    v_and_b32 v2, 3, v1
    v_lshl_add_u32 v6, v2, 3, v6
    s_mov_b32 s20, s50
    s_and_b32 s21, s51, 0xffff
    s_mov_b32 s22, 0x1000000
    s_mov_b32 s23, 0x00020000
    s_lshl_b32 s35, s33, 2
    s_add_u32 s35, s35, s32
    s_mul_i32 s35, s35, 327680
    s_add_u32 s35, s35, 4194304
    v_add_u32 v19, s35, v9
    v_add_u32 v14, 16384, v10
    v_add_u32 v15, 16384, v11
    v_add_u32 v16, 16384, v12
    v_add_u32 v17, 16384, v13
    v_add_u32 v18, 0, v6
    s_waitcnt vmcnt(14)
    s_barrier
    ds_read_b64_tr_b16 a[0:1], v18 offset:0
    ds_read_b64_tr_b16 a[2:3], v18 offset:1024
    ds_read_b128 v[24:27], v14 offset:0
    ds_read_b128 v[28:31], v14 offset:4096
    ds_read_b128 v[32:35], v14 offset:8192
    s_waitcnt lgkmcnt(2)
    v_mfma_f32_32x32x16_bf16 v[80:95], v[24:27], a[0:3], 0
    ds_read_b64_tr_b16 a[4:5], v18 offset:4096
    ds_read_b64_tr_b16 a[6:7], v18 offset:5120
    s_add_u32 s37, s92, 384
    s_and_b32 s37, s37, 0x3ff
    s_add_u32 s91, s37, s93
    s_lshl_b32 s90, s37, 9
    s_add_u32 m0, s39, 86016
    s_add_u32 s43, s90, 0
    buffer_load_dwordx4 v5, s[16:19], s43 offen lds
    s_waitcnt lgkmcnt(3)
    v_mfma_f32_32x32x16_bf16 v[96:111], v[28:31], a[0:3], 0
    ds_read_b128 v[44:47], v15 offset:0
    ds_read_b128 v[48:51], v15 offset:4096
    s_add_u32 m0, s39, 90112
    s_add_u32 s43, s90, 16384
    buffer_load_dwordx4 v5, s[16:19], s43 offen lds
    s_waitcnt lgkmcnt(4)
    v_mfma_f32_32x32x16_bf16 v[112:127], v[32:35], a[0:3], 0
    ds_read_b128 v[52:55], v15 offset:8192
    s_add_u32 m0, s39, 94208
    s_add_u32 s43, s90, 32768
    buffer_load_dwordx4 v5, s[16:19], s43 offen lds
    s_waitcnt lgkmcnt(2)
    v_mfma_f32_32x32x16_bf16 v[80:95], v[44:47], a[4:7], v[80:95]
    ds_read_b64_tr_b16 a[8:9], v18 offset:8192
    ds_read_b64_tr_b16 a[10:11], v18 offset:9216
    s_add_u32 m0, s39, 98304
    s_add_u32 s43, s90, 49152
    buffer_load_dwordx4 v5, s[16:19], s43 offen lds
    s_waitcnt lgkmcnt(3)
    v_mfma_f32_32x32x16_bf16 v[96:111], v[48:51], a[4:7], v[96:111]
    ds_read_b128 v[24:27], v16 offset:0
    ds_read_b128 v[28:31], v16 offset:4096
    s_add_u32 m0, s39, 102400
    s_add_u32 s42, s91, 0
    buffer_load_dwordx4 v4, s[12:15], s42 offen lds
    s_waitcnt lgkmcnt(4)
    v_mfma_f32_32x32x16_bf16 v[112:127], v[52:55], a[4:7], v[112:127]
    ds_read_b128 v[32:35], v16 offset:8192
    s_add_u32 m0, s39, 106496
    s_add_u32 s42, s91, 32768
    buffer_load_dwordx4 v4, s[12:15], s42 offen lds
    s_waitcnt lgkmcnt(2)
    v_mfma_f32_32x32x16_bf16 v[80:95], v[24:27], a[8:11], v[80:95]
    ds_read_b64_tr_b16 a[12:13], v18 offset:12288
    ds_read_b64_tr_b16 a[14:15], v18 offset:13312
    s_add_u32 m0, s39, 110592
    s_add_u32 s42, s91, 65536
    buffer_load_dwordx4 v4, s[12:15], s42 offen lds
    s_waitcnt lgkmcnt(3)
    v_mfma_f32_32x32x16_bf16 v[96:111], v[28:31], a[8:11], v[96:111]
    ds_read_b128 v[44:47], v17 offset:0
    ds_read_b128 v[48:51], v17 offset:4096
    s_waitcnt lgkmcnt(4)
    v_mfma_f32_32x32x16_bf16 v[112:127], v[32:35], a[8:11], v[112:127]
    ds_read_b128 v[52:55], v17 offset:8192
    s_waitcnt lgkmcnt(0)
    s_waitcnt vmcnt(14)
    s_barrier
    v_add_u32 v14, 45056, v10
    v_add_u32 v15, 45056, v11
    v_add_u32 v16, 45056, v12
    v_add_u32 v17, 45056, v13
    v_add_u32 v18, 28672, v6
    v_mfma_f32_32x32x16_bf16 v[80:95], v[44:47], a[12:15], v[80:95]
    ds_read_b64_tr_b16 a[16:17], v18 offset:0
    ds_read_b64_tr_b16 a[18:19], v18 offset:1024
    s_add_u32 s37, s92, 512
    s_and_b32 s37, s37, 0x3ff
    s_add_u32 s91, s37, s93
    s_lshl_b32 s90, s37, 9
    s_add_u32 m0, s39, 0
    s_add_u32 s43, s90, 0
    buffer_load_dwordx4 v5, s[16:19], s43 offen lds
    v_mfma_f32_32x32x16_bf16 v[96:111], v[48:51], a[12:15], v[96:111]
    ds_read_b128 v[24:27], v14 offset:0
    ds_read_b128 v[28:31], v14 offset:4096
    s_add_u32 m0, s39, 4096
    s_add_u32 s43, s90, 16384
    buffer_load_dwordx4 v5, s[16:19], s43 offen lds
    v_mfma_f32_32x32x16_bf16 v[112:127], v[52:55], a[12:15], v[112:127]
    ds_read_b128 v[32:35], v14 offset:8192
    s_add_u32 m0, s39, 8192
    s_add_u32 s43, s90, 32768
    buffer_load_dwordx4 v5, s[16:19], s43 offen lds
    s_waitcnt lgkmcnt(2)
    v_mfma_f32_32x32x16_bf16 v[80:95], v[24:27], a[16:19], v[80:95]
    ds_read_b64_tr_b16 a[20:21], v18 offset:4096
    ds_read_b64_tr_b16 a[22:23], v18 offset:5120
    s_add_u32 m0, s39, 12288
    s_add_u32 s43, s90, 49152
    buffer_load_dwordx4 v5, s[16:19], s43 offen lds
    s_waitcnt lgkmcnt(3)
    v_mfma_f32_32x32x16_bf16 v[96:111], v[28:31], a[16:19], v[96:111]
    ds_read_b128 v[44:47], v15 offset:0
    ds_read_b128 v[48:51], v15 offset:4096
    s_add_u32 m0, s39, 16384
    s_add_u32 s42, s91, 0
    buffer_load_dwordx4 v4, s[12:15], s42 offen lds
    s_waitcnt lgkmcnt(4)
    v_mfma_f32_32x32x16_bf16 v[112:127], v[32:35], a[16:19], v[112:127]
    ds_read_b128 v[52:55], v15 offset:8192
    s_add_u32 m0, s39, 20480
    s_add_u32 s42, s91, 32768
    buffer_load_dwordx4 v4, s[12:15], s42 offen lds
    s_waitcnt lgkmcnt(2)
    v_mfma_f32_32x32x16_bf16 v[80:95], v[44:47], a[20:23], v[80:95]
    ds_read_b64_tr_b16 a[24:25], v18 offset:8192
    ds_read_b64_tr_b16 a[26:27], v18 offset:9216
    s_add_u32 m0, s39, 24576
    s_add_u32 s42, s91, 65536
    buffer_load_dwordx4 v4, s[12:15], s42 offen lds
    s_waitcnt lgkmcnt(3)
    v_mfma_f32_32x32x16_bf16 v[96:111], v[48:51], a[20:23], v[96:111]
    ds_read_b128 v[24:27], v16 offset:0
    ds_read_b128 v[28:31], v16 offset:4096
    s_waitcnt lgkmcnt(4)
    v_mfma_f32_32x32x16_bf16 v[112:127], v[52:55], a[20:23], v[112:127]
    ds_read_b128 v[32:35], v16 offset:8192
    s_waitcnt lgkmcnt(2)
    v_mfma_f32_32x32x16_bf16 v[80:95], v[24:27], a[24:27], v[80:95]
    ds_read_b64_tr_b16 a[28:29], v18 offset:12288
    ds_read_b64_tr_b16 a[30:31], v18 offset:13312
    s_waitcnt lgkmcnt(3)
    v_mfma_f32_32x32x16_bf16 v[96:111], v[28:31], a[24:27], v[96:111]
    ds_read_b128 v[44:47], v17 offset:0
    ds_read_b128 v[48:51], v17 offset:4096
    s_waitcnt lgkmcnt(4)
    v_mfma_f32_32x32x16_bf16 v[112:127], v[32:35], a[24:27], v[112:127]
    ds_read_b128 v[52:55], v17 offset:8192
    s_waitcnt lgkmcnt(0)
    s_waitcnt vmcnt(14)
    s_barrier
    v_add_u32 v14, 73728, v10
    v_add_u32 v15, 73728, v11
    v_add_u32 v16, 73728, v12
    v_add_u32 v17, 73728, v13
    v_add_u32 v18, 57344, v6
    v_mfma_f32_32x32x16_bf16 v[80:95], v[44:47], a[28:31], v[80:95]
    ds_read_b64_tr_b16 a[32:33], v18 offset:0
    ds_read_b64_tr_b16 a[34:35], v18 offset:1024
    s_add_u32 s37, s92, 640
    s_and_b32 s37, s37, 0x3ff
    s_add_u32 s91, s37, s93
    s_lshl_b32 s90, s37, 9
    s_add_u32 m0, s39, 28672
    s_add_u32 s43, s90, 0
    buffer_load_dwordx4 v5, s[16:19], s43 offen lds
    v_mfma_f32_32x32x16_bf16 v[96:111], v[48:51], a[28:31], v[96:111]
    ds_read_b128 v[24:27], v14 offset:0
    ds_read_b128 v[28:31], v14 offset:4096
    s_add_u32 m0, s39, 32768
    s_add_u32 s43, s90, 16384
    buffer_load_dwordx4 v5, s[16:19], s43 offen lds
    v_mfma_f32_32x32x16_bf16 v[112:127], v[52:55], a[28:31], v[112:127]
    ds_read_b128 v[32:35], v14 offset:8192
    s_add_u32 m0, s39, 36864
    s_add_u32 s43, s90, 32768
    buffer_load_dwordx4 v5, s[16:19], s43 offen lds
    s_waitcnt lgkmcnt(2)
    v_mfma_f32_32x32x16_bf16 v[80:95], v[24:27], a[32:35], v[80:95]
    ds_read_b64_tr_b16 a[36:37], v18 offset:4096
    ds_read_b64_tr_b16 a[38:39], v18 offset:5120
    s_add_u32 m0, s39, 40960
    s_add_u32 s43, s90, 49152
    buffer_load_dwordx4 v5, s[16:19], s43 offen lds
    s_waitcnt lgkmcnt(3)
    v_mfma_f32_32x32x16_bf16 v[96:111], v[28:31], a[32:35], v[96:111]
    ds_read_b128 v[44:47], v15 offset:0
    ds_read_b128 v[48:51], v15 offset:4096
    s_add_u32 m0, s39, 45056
    s_add_u32 s42, s91, 0
    buffer_load_dwordx4 v4, s[12:15], s42 offen lds
    s_waitcnt lgkmcnt(4)
    v_mfma_f32_32x32x16_bf16 v[112:127], v[32:35], a[32:35], v[112:127]
    ds_read_b128 v[52:55], v15 offset:8192
    s_add_u32 m0, s39, 49152
    s_add_u32 s42, s91, 32768
    buffer_load_dwordx4 v4, s[12:15], s42 offen lds
    s_waitcnt lgkmcnt(2)
    v_mfma_f32_32x32x16_bf16 v[80:95], v[44:47], a[36:39], v[80:95]
    ds_read_b64_tr_b16 a[40:41], v18 offset:8192
    ds_read_b64_tr_b16 a[42:43], v18 offset:9216
    s_add_u32 m0, s39, 53248
    s_add_u32 s42, s91, 65536
    buffer_load_dwordx4 v4, s[12:15], s42 offen lds
    s_waitcnt lgkmcnt(3)
    v_mfma_f32_32x32x16_bf16 v[96:111], v[48:51], a[36:39], v[96:111]
    ds_read_b128 v[24:27], v16 offset:0
    ds_read_b128 v[28:31], v16 offset:4096
    s_waitcnt lgkmcnt(4)
    v_mfma_f32_32x32x16_bf16 v[112:127], v[52:55], a[36:39], v[112:127]
    ds_read_b128 v[32:35], v16 offset:8192
    s_waitcnt lgkmcnt(2)
    v_mfma_f32_32x32x16_bf16 v[80:95], v[24:27], a[40:43], v[80:95]
    ds_read_b64_tr_b16 a[44:45], v18 offset:12288
    ds_read_b64_tr_b16 a[46:47], v18 offset:13312
    s_waitcnt lgkmcnt(3)
    v_mfma_f32_32x32x16_bf16 v[96:111], v[28:31], a[40:43], v[96:111]
    ds_read_b128 v[44:47], v17 offset:0
    ds_read_b128 v[48:51], v17 offset:4096
    s_waitcnt lgkmcnt(4)
    v_mfma_f32_32x32x16_bf16 v[112:127], v[32:35], a[40:43], v[112:127]
    ds_read_b128 v[52:55], v17 offset:8192
    s_waitcnt lgkmcnt(0)
    s_waitcnt vmcnt(14)
    s_barrier
    v_add_u32 v14, 102400, v10
    v_add_u32 v15, 102400, v11
    v_add_u32 v16, 102400, v12
    v_add_u32 v17, 102400, v13
    v_add_u32 v18, 86016, v6
    v_mfma_f32_32x32x16_bf16 v[80:95], v[44:47], a[44:47], v[80:95]
    ds_read_b64_tr_b16 a[48:49], v18 offset:0
    ds_read_b64_tr_b16 a[50:51], v18 offset:1024
    s_add_u32 s37, s92, 768
    s_and_b32 s37, s37, 0x3ff
    s_add_u32 s91, s37, s93
    s_lshl_b32 s90, s37, 9
    s_add_u32 m0, s39, 57344
    s_add_u32 s43, s90, 0
    buffer_load_dwordx4 v5, s[16:19], s43 offen lds
    v_mfma_f32_32x32x16_bf16 v[96:111], v[48:51], a[44:47], v[96:111]
    ds_read_b128 v[24:27], v14 offset:0
    ds_read_b128 v[28:31], v14 offset:4096
    s_add_u32 m0, s39, 61440
    s_add_u32 s43, s90, 16384
    buffer_load_dwordx4 v5, s[16:19], s43 offen lds
    v_mfma_f32_32x32x16_bf16 v[112:127], v[52:55], a[44:47], v[112:127]
    ds_read_b128 v[32:35], v14 offset:8192
    s_add_u32 m0, s39, 65536
    s_add_u32 s43, s90, 32768
    buffer_load_dwordx4 v5, s[16:19], s43 offen lds
    s_waitcnt lgkmcnt(2)
    v_mfma_f32_32x32x16_bf16 v[80:95], v[24:27], a[48:51], v[80:95]
    ds_read_b64_tr_b16 a[52:53], v18 offset:4096
    ds_read_b64_tr_b16 a[54:55], v18 offset:5120
    s_add_u32 m0, s39, 69632
    s_add_u32 s43, s90, 49152
    buffer_load_dwordx4 v5, s[16:19], s43 offen lds
    s_waitcnt lgkmcnt(3)
    v_mfma_f32_32x32x16_bf16 v[96:111], v[28:31], a[48:51], v[96:111]
    ds_read_b128 v[44:47], v15 offset:0
    ds_read_b128 v[48:51], v15 offset:4096
    s_add_u32 m0, s39, 73728
    s_add_u32 s42, s91, 0
    buffer_load_dwordx4 v4, s[12:15], s42 offen lds
    s_waitcnt lgkmcnt(4)
    v_mfma_f32_32x32x16_bf16 v[112:127], v[32:35], a[48:51], v[112:127]
    ds_read_b128 v[52:55], v15 offset:8192
    s_add_u32 m0, s39, 77824
    s_add_u32 s42, s91, 32768
    buffer_load_dwordx4 v4, s[12:15], s42 offen lds
    s_waitcnt lgkmcnt(2)
    v_mfma_f32_32x32x16_bf16 v[80:95], v[44:47], a[52:55], v[80:95]
    ds_read_b64_tr_b16 a[56:57], v18 offset:8192
    ds_read_b64_tr_b16 a[58:59], v18 offset:9216
    s_add_u32 m0, s39, 81920
    s_add_u32 s42, s91, 65536
    buffer_load_dwordx4 v4, s[12:15], s42 offen lds
    s_waitcnt lgkmcnt(3)
    v_mfma_f32_32x32x16_bf16 v[96:111], v[48:51], a[52:55], v[96:111]
    ds_read_b128 v[24:27], v16 offset:0
    ds_read_b128 v[28:31], v16 offset:4096
    s_waitcnt lgkmcnt(4)
    v_mfma_f32_32x32x16_bf16 v[112:127], v[52:55], a[52:55], v[112:127]
    ds_read_b128 v[32:35], v16 offset:8192
    s_waitcnt lgkmcnt(2)
    v_mfma_f32_32x32x16_bf16 v[80:95], v[24:27], a[56:59], v[80:95]
    ds_read_b64_tr_b16 a[60:61], v18 offset:12288
    ds_read_b64_tr_b16 a[62:63], v18 offset:13312
    s_waitcnt lgkmcnt(3)
    v_mfma_f32_32x32x16_bf16 v[96:111], v[28:31], a[56:59], v[96:111]
    ds_read_b128 v[44:47], v17 offset:0
    ds_read_b128 v[48:51], v17 offset:4096
    s_waitcnt lgkmcnt(4)
    v_mfma_f32_32x32x16_bf16 v[112:127], v[32:35], a[56:59], v[112:127]
    ds_read_b128 v[52:55], v17 offset:8192
    s_waitcnt lgkmcnt(0)
    s_waitcnt vmcnt(14)
    s_barrier
    v_add_u32 v14, 16384, v10
    v_add_u32 v15, 16384, v11
    v_add_u32 v16, 16384, v12
    v_add_u32 v17, 16384, v13
    v_add_u32 v18, 0, v6
    v_mfma_f32_32x32x16_bf16 v[80:95], v[44:47], a[60:63], v[80:95]
    ds_read_b64_tr_b16 a[64:65], v18 offset:0
    ds_read_b64_tr_b16 a[66:67], v18 offset:1024
    s_add_u32 s37, s92, 896
    s_and_b32 s37, s37, 0x3ff
    s_add_u32 s91, s37, s93
    s_lshl_b32 s90, s37, 9
    s_add_u32 m0, s39, 86016
    s_add_u32 s43, s90, 0
    buffer_load_dwordx4 v5, s[16:19], s43 offen lds
    v_mfma_f32_32x32x16_bf16 v[96:111], v[48:51], a[60:63], v[96:111]
    ds_read_b128 v[24:27], v14 offset:0
    ds_read_b128 v[28:31], v14 offset:4096
    s_add_u32 m0, s39, 90112
    s_add_u32 s43, s90, 16384
    buffer_load_dwordx4 v5, s[16:19], s43 offen lds
    v_mfma_f32_32x32x16_bf16 v[112:127], v[52:55], a[60:63], v[112:127]
    ds_read_b128 v[32:35], v14 offset:8192
    s_add_u32 m0, s39, 94208
    s_add_u32 s43, s90, 32768
    buffer_load_dwordx4 v5, s[16:19], s43 offen lds
    s_waitcnt lgkmcnt(2)
    v_mfma_f32_32x32x16_bf16 v[80:95], v[24:27], a[64:67], v[80:95]
    ds_read_b64_tr_b16 a[68:69], v18 offset:4096
    ds_read_b64_tr_b16 a[70:71], v18 offset:5120
    s_add_u32 m0, s39, 98304
    s_add_u32 s43, s90, 49152
    buffer_load_dwordx4 v5, s[16:19], s43 offen lds
    s_waitcnt lgkmcnt(3)
    v_mfma_f32_32x32x16_bf16 v[96:111], v[28:31], a[64:67], v[96:111]
    ds_read_b128 v[44:47], v15 offset:0
    ds_read_b128 v[48:51], v15 offset:4096
    s_add_u32 m0, s39, 102400
    s_add_u32 s42, s91, 0
    buffer_load_dwordx4 v4, s[12:15], s42 offen lds
    s_waitcnt lgkmcnt(4)
    v_mfma_f32_32x32x16_bf16 v[112:127], v[32:35], a[64:67], v[112:127]
    ds_read_b128 v[52:55], v15 offset:8192
    s_add_u32 m0, s39, 106496
    s_add_u32 s42, s91, 32768
    buffer_load_dwordx4 v4, s[12:15], s42 offen lds
    s_waitcnt lgkmcnt(2)
    v_mfma_f32_32x32x16_bf16 v[80:95], v[44:47], a[68:71], v[80:95]
    ds_read_b64_tr_b16 a[72:73], v18 offset:8192
    ds_read_b64_tr_b16 a[74:75], v18 offset:9216
    s_add_u32 m0, s39, 110592
    s_add_u32 s42, s91, 65536
    buffer_load_dwordx4 v4, s[12:15], s42 offen lds
    s_waitcnt lgkmcnt(3)
    v_mfma_f32_32x32x16_bf16 v[96:111], v[48:51], a[68:71], v[96:111]
    ds_read_b128 v[24:27], v16 offset:0
    ds_read_b128 v[28:31], v16 offset:4096
    s_add_u32 s37, s92, 0
    s_and_b32 s37, s37, 0x3ff
    s_add_u32 s91, s37, s93
    s_lshl_b32 s90, s37, 9
    s_add_u32 m0, s39, 114688
    s_add_u32 s42, s91, 98304
    buffer_load_dwordx4 v4, s[12:15], s42 offen lds
    s_waitcnt lgkmcnt(4)
    v_mfma_f32_32x32x16_bf16 v[112:127], v[52:55], a[68:71], v[112:127]
    ds_read_b128 v[32:35], v16 offset:8192
    s_add_u32 s37, s92, 128
    s_and_b32 s37, s37, 0x3ff
    s_add_u32 s91, s37, s93
    s_lshl_b32 s90, s37, 9
    s_add_u32 m0, s39, 118784
    s_add_u32 s42, s91, 98304
    buffer_load_dwordx4 v4, s[12:15], s42 offen lds
    s_waitcnt lgkmcnt(2)
    v_mfma_f32_32x32x16_bf16 v[80:95], v[24:27], a[72:75], v[80:95]
    ds_read_b64_tr_b16 a[76:77], v18 offset:12288
    ds_read_b64_tr_b16 a[78:79], v18 offset:13312
    s_add_u32 s37, s92, 256
    s_and_b32 s37, s37, 0x3ff
    s_add_u32 s91, s37, s93
    s_lshl_b32 s90, s37, 9
    s_add_u32 m0, s39, 122880
    s_add_u32 s42, s91, 98304
    buffer_load_dwordx4 v4, s[12:15], s42 offen lds
    s_waitcnt lgkmcnt(3)
    v_mfma_f32_32x32x16_bf16 v[96:111], v[28:31], a[72:75], v[96:111]
    ds_read_b128 v[44:47], v17 offset:0
    ds_read_b128 v[48:51], v17 offset:4096
    s_add_u32 s37, s92, 384
    s_and_b32 s37, s37, 0x3ff
    s_add_u32 s91, s37, s93
    s_lshl_b32 s90, s37, 9
    s_add_u32 m0, s39, 126976
    s_add_u32 s42, s91, 98304
    buffer_load_dwordx4 v4, s[12:15], s42 offen lds
    s_waitcnt lgkmcnt(4)
    v_mfma_f32_32x32x16_bf16 v[112:127], v[32:35], a[72:75], v[112:127]
    ds_read_b128 v[52:55], v17 offset:8192
    s_add_u32 s37, s92, 512
    s_and_b32 s37, s37, 0x3ff
    s_add_u32 s91, s37, s93
    s_lshl_b32 s90, s37, 9
    s_add_u32 m0, s39, 131072
    s_add_u32 s42, s91, 98304
    buffer_load_dwordx4 v4, s[12:15], s42 offen lds
    s_waitcnt lgkmcnt(0)
    s_waitcnt vmcnt(19)
    s_barrier
    v_add_u32 v14, 45056, v10
    v_add_u32 v15, 45056, v11
    v_add_u32 v16, 45056, v12
    v_add_u32 v17, 45056, v13
    v_add_u32 v18, 28672, v6
    v_mfma_f32_32x32x16_bf16 v[80:95], v[44:47], a[76:79], v[80:95]
    ds_read_b64_tr_b16 a[80:81], v18 offset:0
    ds_read_b64_tr_b16 a[82:83], v18 offset:1024
    s_add_u32 s37, s92, 640
    s_and_b32 s37, s37, 0x3ff
    s_add_u32 s91, s37, s93
    s_lshl_b32 s90, s37, 9
    s_add_u32 m0, s39, 135168
    s_add_u32 s42, s91, 98304
    buffer_load_dwordx4 v4, s[12:15], s42 offen lds
    v_mfma_f32_32x32x16_bf16 v[96:111], v[48:51], a[76:79], v[96:111]
    ds_read_b128 v[24:27], v14 offset:0
    ds_read_b128 v[28:31], v14 offset:4096
    s_add_u32 s37, s92, 768
    s_and_b32 s37, s37, 0x3ff
    s_add_u32 s91, s37, s93
    s_lshl_b32 s90, s37, 9
    s_add_u32 m0, s39, 139264
    s_add_u32 s42, s91, 98304
    buffer_load_dwordx4 v4, s[12:15], s42 offen lds
    v_mfma_f32_32x32x16_bf16 v[112:127], v[52:55], a[76:79], v[112:127]
    ds_read_b128 v[32:35], v14 offset:8192
    s_add_u32 s37, s92, 896
    s_and_b32 s37, s37, 0x3ff
    s_add_u32 s91, s37, s93
    s_lshl_b32 s90, s37, 9
    s_add_u32 m0, s39, 143360
    s_add_u32 s42, s91, 98304
    buffer_load_dwordx4 v4, s[12:15], s42 offen lds
    buffer_load_dword v21, v22, s[28:31], 0 offen sc1
    s_waitcnt lgkmcnt(2)
    v_mfma_f32_32x32x16_bf16 v[80:95], v[24:27], a[80:83], v[80:95]
    ds_read_b64_tr_b16 a[84:85], v18 offset:4096
    ds_read_b64_tr_b16 a[86:87], v18 offset:5120
    s_waitcnt lgkmcnt(3)
    v_mfma_f32_32x32x16_bf16 v[96:111], v[28:31], a[80:83], v[96:111]
    ds_read_b128 v[44:47], v15 offset:0
    ds_read_b128 v[48:51], v15 offset:4096
    s_waitcnt lgkmcnt(4)
    v_mfma_f32_32x32x16_bf16 v[112:127], v[32:35], a[80:83], v[112:127]
    ds_read_b128 v[52:55], v15 offset:8192
    s_waitcnt lgkmcnt(2)
    v_mfma_f32_32x32x16_bf16 v[80:95], v[44:47], a[84:87], v[80:95]
    ds_read_b64_tr_b16 a[88:89], v18 offset:8192
    ds_read_b64_tr_b16 a[90:91], v18 offset:9216
    s_waitcnt lgkmcnt(3)
    v_mfma_f32_32x32x16_bf16 v[96:111], v[48:51], a[84:87], v[96:111]
    ds_read_b128 v[24:27], v16 offset:0
    ds_read_b128 v[28:31], v16 offset:4096
    s_waitcnt lgkmcnt(4)
    v_mfma_f32_32x32x16_bf16 v[112:127], v[52:55], a[84:87], v[112:127]
    ds_read_b128 v[32:35], v16 offset:8192
    s_waitcnt lgkmcnt(2)
    v_mfma_f32_32x32x16_bf16 v[80:95], v[24:27], a[88:91], v[80:95]
    ds_read_b64_tr_b16 a[92:93], v18 offset:12288
    ds_read_b64_tr_b16 a[94:95], v18 offset:13312
    s_waitcnt lgkmcnt(3)
    v_mfma_f32_32x32x16_bf16 v[96:111], v[28:31], a[88:91], v[96:111]
    ds_read_b128 v[44:47], v17 offset:0
    ds_read_b128 v[48:51], v17 offset:4096
    s_waitcnt lgkmcnt(4)
    v_mfma_f32_32x32x16_bf16 v[112:127], v[32:35], a[88:91], v[112:127]
    ds_read_b128 v[52:55], v17 offset:8192
    s_waitcnt lgkmcnt(0)
    s_waitcnt vmcnt(16)
    s_barrier
    v_add_u32 v14, 73728, v10
    v_add_u32 v15, 73728, v11
    v_add_u32 v16, 73728, v12
    v_add_u32 v17, 73728, v13
    v_add_u32 v18, 57344, v6
    v_mfma_f32_32x32x16_bf16 v[80:95], v[44:47], a[92:95], v[80:95]
    ds_read_b64_tr_b16 a[96:97], v18 offset:0
    ds_read_b64_tr_b16 a[98:99], v18 offset:1024
    s_add_u32 s37, s92, 0
    s_and_b32 s37, s37, 0x3ff
    s_add_u32 s91, s37, s93
    s_lshl_b32 s90, s37, 9
    s_add_u32 m0, s39, 0
    s_add_u32 s42, s91, 131072
    buffer_load_dwordx4 v4, s[12:15], s42 offen lds
    v_mfma_f32_32x32x16_bf16 v[96:111], v[48:51], a[92:95], v[96:111]
    ds_read_b128 v[24:27], v14 offset:0
    ds_read_b128 v[28:31], v14 offset:4096
    s_add_u32 s37, s92, 128
    s_and_b32 s37, s37, 0x3ff
    s_add_u32 s91, s37, s93
    s_lshl_b32 s90, s37, 9
    s_add_u32 m0, s39, 4096
    s_add_u32 s42, s91, 131072
    buffer_load_dwordx4 v4, s[12:15], s42 offen lds
    v_mfma_f32_32x32x16_bf16 v[112:127], v[52:55], a[92:95], v[112:127]
    ds_read_b128 v[32:35], v14 offset:8192
    s_add_u32 s37, s92, 256
    s_and_b32 s37, s37, 0x3ff
    s_add_u32 s91, s37, s93
    s_lshl_b32 s90, s37, 9
    s_add_u32 m0, s39, 8192
    s_add_u32 s42, s91, 131072
    buffer_load_dwordx4 v4, s[12:15], s42 offen lds
    s_waitcnt lgkmcnt(2)
    v_mfma_f32_32x32x16_bf16 v[80:95], v[24:27], a[96:99], v[80:95]
    ds_read_b64_tr_b16 a[100:101], v18 offset:4096
    ds_read_b64_tr_b16 a[102:103], v18 offset:5120
    s_add_u32 s37, s92, 384
    s_and_b32 s37, s37, 0x3ff
    s_add_u32 s91, s37, s93
    s_lshl_b32 s90, s37, 9
    s_add_u32 m0, s39, 12288
    s_add_u32 s42, s91, 131072
    buffer_load_dwordx4 v4, s[12:15], s42 offen lds
    s_waitcnt lgkmcnt(3)
    v_mfma_f32_32x32x16_bf16 v[96:111], v[28:31], a[96:99], v[96:111]
    ds_read_b128 v[44:47], v15 offset:0
    ds_read_b128 v[48:51], v15 offset:4096
    s_add_u32 s37, s92, 512
    s_and_b32 s37, s37, 0x3ff
    s_add_u32 s91, s37, s93
    s_lshl_b32 s90, s37, 9
    s_add_u32 m0, s39, 16384
    s_add_u32 s42, s91, 131072
    buffer_load_dwordx4 v4, s[12:15], s42 offen lds
    s_waitcnt lgkmcnt(4)
    v_mfma_f32_32x32x16_bf16 v[112:127], v[32:35], a[96:99], v[112:127]
    ds_read_b128 v[52:55], v15 offset:8192
    s_add_u32 s37, s92, 640
    s_and_b32 s37, s37, 0x3ff
    s_add_u32 s91, s37, s93
    s_lshl_b32 s90, s37, 9
    s_add_u32 m0, s39, 20480
    s_add_u32 s42, s91, 131072
    buffer_load_dwordx4 v4, s[12:15], s42 offen lds
    s_waitcnt lgkmcnt(2)
    v_mfma_f32_32x32x16_bf16 v[80:95], v[44:47], a[100:103], v[80:95]
    ds_read_b64_tr_b16 a[104:105], v18 offset:8192
    ds_read_b64_tr_b16 a[106:107], v18 offset:9216
    s_add_u32 s37, s92, 768
    s_and_b32 s37, s37, 0x3ff
    s_add_u32 s91, s37, s93
    s_lshl_b32 s90, s37, 9
    s_add_u32 m0, s39, 24576
    s_add_u32 s42, s91, 131072
    buffer_load_dwordx4 v4, s[12:15], s42 offen lds
    s_waitcnt lgkmcnt(3)
    v_mfma_f32_32x32x16_bf16 v[96:111], v[48:51], a[100:103], v[96:111]
    ds_read_b128 v[24:27], v16 offset:0
    ds_read_b128 v[28:31], v16 offset:4096
    s_add_u32 s37, s92, 896
    s_and_b32 s37, s37, 0x3ff
    s_add_u32 s91, s37, s93
    s_lshl_b32 s90, s37, 9
    s_add_u32 m0, s39, 28672
    s_add_u32 s42, s91, 131072
    buffer_load_dwordx4 v4, s[12:15], s42 offen lds
    s_waitcnt lgkmcnt(4)
    v_mfma_f32_32x32x16_bf16 v[112:127], v[52:55], a[100:103], v[112:127]
    ds_read_b128 v[32:35], v16 offset:8192
    s_waitcnt lgkmcnt(2)
    v_mfma_f32_32x32x16_bf16 v[80:95], v[24:27], a[104:107], v[80:95]
    ds_read_b64_tr_b16 a[108:109], v18 offset:12288
    ds_read_b64_tr_b16 a[110:111], v18 offset:13312
    s_waitcnt lgkmcnt(3)
    v_mfma_f32_32x32x16_bf16 v[96:111], v[28:31], a[104:107], v[96:111]
    ds_read_b128 v[44:47], v17 offset:0
    ds_read_b128 v[48:51], v17 offset:4096
    s_waitcnt lgkmcnt(4)
    v_mfma_f32_32x32x16_bf16 v[112:127], v[32:35], a[104:107], v[112:127]
    ds_read_b128 v[52:55], v17 offset:8192
    s_waitcnt lgkmcnt(0)
    s_waitcnt vmcnt(17)
    s_barrier
    v_add_u32 v14, 102400, v10
    v_add_u32 v15, 102400, v11
    v_add_u32 v16, 102400, v12
    v_add_u32 v17, 102400, v13
    v_add_u32 v18, 86016, v6
    v_mfma_f32_32x32x16_bf16 v[80:95], v[44:47], a[108:111], v[80:95]
    ds_read_b64_tr_b16 a[112:113], v18 offset:0
    ds_read_b64_tr_b16 a[114:115], v18 offset:1024
    v_mfma_f32_32x32x16_bf16 v[96:111], v[48:51], a[108:111], v[96:111]
    ds_read_b128 v[24:27], v14 offset:0
    ds_read_b128 v[28:31], v14 offset:4096
    v_mfma_f32_32x32x16_bf16 v[112:127], v[52:55], a[108:111], v[112:127]
    ds_read_b128 v[32:35], v14 offset:8192
    s_waitcnt lgkmcnt(2)
    v_mfma_f32_32x32x16_bf16 v[80:95], v[24:27], a[112:115], v[80:95]
    ds_read_b64_tr_b16 a[116:117], v18 offset:4096
    ds_read_b64_tr_b16 a[118:119], v18 offset:5120
    s_waitcnt lgkmcnt(3)
    v_mfma_f32_32x32x16_bf16 v[96:111], v[28:31], a[112:115], v[96:111]
    ds_read_b128 v[44:47], v15 offset:0
    ds_read_b128 v[48:51], v15 offset:4096
    s_waitcnt lgkmcnt(4)
    v_mfma_f32_32x32x16_bf16 v[112:127], v[32:35], a[112:115], v[112:127]
    ds_read_b128 v[52:55], v15 offset:8192
    s_waitcnt lgkmcnt(2)
    v_mfma_f32_32x32x16_bf16 v[80:95], v[44:47], a[116:119], v[80:95]
    ds_read_b64_tr_b16 a[120:121], v18 offset:8192
    ds_read_b64_tr_b16 a[122:123], v18 offset:9216
    s_waitcnt lgkmcnt(3)
    v_mfma_f32_32x32x16_bf16 v[96:111], v[48:51], a[116:119], v[96:111]
    ds_read_b128 v[24:27], v16 offset:0
    ds_read_b128 v[28:31], v16 offset:4096
    s_waitcnt lgkmcnt(4)
    v_mfma_f32_32x32x16_bf16 v[112:127], v[52:55], a[116:119], v[112:127]
    ds_read_b128 v[32:35], v16 offset:8192
    s_waitcnt lgkmcnt(2)
    v_mfma_f32_32x32x16_bf16 v[80:95], v[24:27], a[120:123], v[80:95]
    ds_read_b64_tr_b16 a[124:125], v18 offset:12288
    ds_read_b64_tr_b16 a[126:127], v18 offset:13312
    s_waitcnt lgkmcnt(3)
    v_mfma_f32_32x32x16_bf16 v[96:111], v[28:31], a[120:123], v[96:111]
    ds_read_b128 v[44:47], v17 offset:0
    ds_read_b128 v[48:51], v17 offset:4096
    s_waitcnt lgkmcnt(4)
    v_mfma_f32_32x32x16_bf16 v[112:127], v[32:35], a[120:123], v[112:127]
    ds_read_b128 v[52:55], v17 offset:8192
    s_waitcnt lgkmcnt(2)
    v_mfma_f32_32x32x16_bf16 v[80:95], v[44:47], a[124:127], v[80:95]
    s_waitcnt lgkmcnt(1)
    v_mfma_f32_32x32x16_bf16 v[96:111], v[48:51], a[124:127], v[96:111]
    s_waitcnt lgkmcnt(0)
    v_mfma_f32_32x32x16_bf16 v[112:127], v[52:55], a[124:127], v[112:127]
    s_waitcnt vmcnt(9)
    s_barrier
    v_add_u32 v14, 114688, v10
    v_add_u32 v15, 114688, v11
    v_add_u32 v16, 114688, v12
    v_add_u32 v17, 114688, v13
    ds_read_b128 v[200:203], v14 offset:0
    ds_read_b128 v[204:207], v15 offset:0
    ds_read_b128 v[208:211], v16 offset:0
    ds_read_b128 v[212:215], v17 offset:0
    ds_read_b128 v[216:219], v14 offset:4096
    ds_read_b128 v[220:223], v15 offset:4096
    s_waitcnt lgkmcnt(5)
    v_mfma_f32_32x32x16_bf16 v[128:143], v[200:203], a[0:3], 0
    ds_read_b128 v[224:227], v16 offset:4096
    s_waitcnt lgkmcnt(5)
    v_mfma_f32_32x32x16_bf16 v[128:143], v[204:207], a[4:7], v[128:143]
    ds_read_b128 v[228:231], v17 offset:4096
    s_add_u32 s35, s38, 0
    s_lshr_b32 s36, s35, 9
    s_waitcnt lgkmcnt(5)
    v_mfma_f32_32x32x16_bf16 v[128:143], v[208:211], a[8:11], v[128:143]
    ds_read_b128 v[200:203], v14 offset:8192
    s_and_b32 s35, s35, 511
    s_lshr_b32 s35, s35, 4
    s_waitcnt lgkmcnt(5)
    v_mfma_f32_32x32x16_bf16 v[128:143], v[212:215], a[12:15], v[128:143]
    ds_read_b128 v[204:207], v15 offset:8192
    s_mul_i32 s35, s35, 10
    s_add_u32 s35, s35, s36
    s_waitcnt lgkmcnt(5)
    v_mfma_f32_32x32x16_bf16 v[128:143], v[216:219], a[16:19], v[128:143]
    ds_read_b128 v[208:211], v16 offset:8192
    s_lshl_b32 s35, s35, 10
    s_add_u32 s36, s35, 10240
    s_waitcnt lgkmcnt(5)
    v_mfma_f32_32x32x16_bf16 v[128:143], v[220:223], a[20:23], v[128:143]
    ds_read_b128 v[212:215], v17 offset:8192
    v_cvt_pk_bf16_f32 v160, v80, v81
    v_cvt_pk_bf16_f32 v161, v82, v83
    s_waitcnt lgkmcnt(5)
    v_mfma_f32_32x32x16_bf16 v[128:143], v[224:227], a[24:27], v[128:143]
    ds_read_b128 v[216:219], v14 offset:12288
    v_cvt_pk_bf16_f32 v162, v84, v85
    v_cvt_pk_bf16_f32 v163, v86, v87
    s_waitcnt lgkmcnt(5)
    v_mfma_f32_32x32x16_bf16 v[128:143], v[228:231], a[28:31], v[128:143]
    ds_read_b128 v[220:223], v15 offset:12288
    buffer_store_dwordx4 v[160:163], v19, s[20:23], s35 offen sc1
    v_cvt_pk_bf16_f32 v164, v88, v89
    s_waitcnt lgkmcnt(5)
    v_mfma_f32_32x32x16_bf16 v[128:143], v[200:203], a[32:35], v[128:143]
    ds_read_b128 v[224:227], v16 offset:12288
    v_cvt_pk_bf16_f32 v165, v90, v91
    v_cvt_pk_bf16_f32 v166, v92, v93
    s_waitcnt lgkmcnt(5)
    v_mfma_f32_32x32x16_bf16 v[128:143], v[204:207], a[36:39], v[128:143]
    ds_read_b128 v[228:231], v17 offset:12288
    v_cvt_pk_bf16_f32 v167, v94, v95
    buffer_store_dwordx4 v[164:167], v19, s[20:23], s36 offen sc1
    s_waitcnt lgkmcnt(5)
    v_mfma_f32_32x32x16_bf16 v[128:143], v[208:211], a[40:43], v[128:143]
    ds_read_b128 v[200:203], v14 offset:16384
    s_add_u32 s35, s38, 32
    s_lshr_b32 s36, s35, 9
    s_waitcnt lgkmcnt(5)
    v_mfma_f32_32x32x16_bf16 v[128:143], v[212:215], a[44:47], v[128:143]
    ds_read_b128 v[204:207], v15 offset:16384
    s_and_b32 s35, s35, 511
    s_lshr_b32 s35, s35, 4
    s_waitcnt lgkmcnt(5)
    v_mfma_f32_32x32x16_bf16 v[128:143], v[216:219], a[48:51], v[128:143]
    ds_read_b128 v[208:211], v16 offset:16384
    s_mul_i32 s35, s35, 10
    s_add_u32 s35, s35, s36
    s_waitcnt lgkmcnt(5)
    v_mfma_f32_32x32x16_bf16 v[128:143], v[220:223], a[52:55], v[128:143]
    ds_read_b128 v[212:215], v17 offset:16384
    s_lshl_b32 s35, s35, 10
    s_add_u32 s36, s35, 10240
    s_waitcnt lgkmcnt(5)
    v_mfma_f32_32x32x16_bf16 v[128:143], v[224:227], a[56:59], v[128:143]
    ds_read_b128 v[216:219], v14 offset:20480
    v_cvt_pk_bf16_f32 v168, v96, v97
    v_cvt_pk_bf16_f32 v169, v98, v99
    s_waitcnt lgkmcnt(5)
    v_mfma_f32_32x32x16_bf16 v[128:143], v[228:231], a[60:63], v[128:143]
    ds_read_b128 v[220:223], v15 offset:20480
    v_cvt_pk_bf16_f32 v170, v100, v101
    v_cvt_pk_bf16_f32 v171, v102, v103
    s_waitcnt lgkmcnt(5)
    v_mfma_f32_32x32x16_bf16 v[128:143], v[200:203], a[64:67], v[128:143]
    ds_read_b128 v[224:227], v16 offset:20480
    buffer_store_dwordx4 v[168:171], v19, s[20:23], s35 offen sc1
    v_cvt_pk_bf16_f32 v172, v104, v105
    s_waitcnt lgkmcnt(5)
    v_mfma_f32_32x32x16_bf16 v[128:143], v[204:207], a[68:71], v[128:143]
    ds_read_b128 v[228:231], v17 offset:20480
    v_cvt_pk_bf16_f32 v173, v106, v107
    v_cvt_pk_bf16_f32 v174, v108, v109
    s_waitcnt lgkmcnt(5)
    v_mfma_f32_32x32x16_bf16 v[128:143], v[208:211], a[72:75], v[128:143]
    ds_read_b128 v[200:203], v14 offset:24576
    v_cvt_pk_bf16_f32 v175, v110, v111
    buffer_store_dwordx4 v[172:175], v19, s[20:23], s36 offen sc1
    s_waitcnt lgkmcnt(5)
    v_mfma_f32_32x32x16_bf16 v[128:143], v[212:215], a[76:79], v[128:143]
    ds_read_b128 v[204:207], v15 offset:24576
    s_add_u32 s35, s38, 64
    s_lshr_b32 s36, s35, 9
    s_waitcnt lgkmcnt(5)
    v_mfma_f32_32x32x16_bf16 v[128:143], v[216:219], a[80:83], v[128:143]
    ds_read_b128 v[208:211], v16 offset:24576
    s_and_b32 s35, s35, 511
    s_lshr_b32 s35, s35, 4
    s_waitcnt lgkmcnt(5)
    v_mfma_f32_32x32x16_bf16 v[128:143], v[220:223], a[84:87], v[128:143]
    ds_read_b128 v[212:215], v17 offset:24576
    s_mul_i32 s35, s35, 10
    s_add_u32 s35, s35, s36
    s_waitcnt lgkmcnt(5)
    v_mfma_f32_32x32x16_bf16 v[128:143], v[224:227], a[88:91], v[128:143]
    ds_read_b128 v[216:219], v14 offset:28672
    s_lshl_b32 s35, s35, 10
    s_add_u32 s36, s35, 10240
    s_waitcnt lgkmcnt(5)
    v_mfma_f32_32x32x16_bf16 v[128:143], v[228:231], a[92:95], v[128:143]
    ds_read_b128 v[220:223], v15 offset:28672
    v_cvt_pk_bf16_f32 v176, v112, v113
    v_cvt_pk_bf16_f32 v177, v114, v115
    s_waitcnt lgkmcnt(5)
    v_mfma_f32_32x32x16_bf16 v[128:143], v[200:203], a[96:99], v[128:143]
    ds_read_b128 v[224:227], v16 offset:28672
    v_cvt_pk_bf16_f32 v178, v116, v117
    v_cvt_pk_bf16_f32 v179, v118, v119
    s_waitcnt lgkmcnt(5)
    v_mfma_f32_32x32x16_bf16 v[128:143], v[204:207], a[100:103], v[128:143]
    ds_read_b128 v[228:231], v17 offset:28672
    buffer_store_dwordx4 v[176:179], v19, s[20:23], s35 offen sc1
    v_cvt_pk_bf16_f32 v180, v120, v121
    s_waitcnt lgkmcnt(5)
    v_mfma_f32_32x32x16_bf16 v[128:143], v[208:211], a[104:107], v[128:143]
    v_cvt_pk_bf16_f32 v181, v122, v123
    v_cvt_pk_bf16_f32 v182, v124, v125
    s_waitcnt lgkmcnt(4)
    v_mfma_f32_32x32x16_bf16 v[128:143], v[212:215], a[108:111], v[128:143]
    v_cvt_pk_bf16_f32 v183, v126, v127
    buffer_store_dwordx4 v[180:183], v19, s[20:23], s36 offen sc1
    s_waitcnt lgkmcnt(3)
    v_mfma_f32_32x32x16_bf16 v[128:143], v[216:219], a[112:115], v[128:143]
    s_waitcnt lgkmcnt(2)
    v_mfma_f32_32x32x16_bf16 v[128:143], v[220:223], a[116:119], v[128:143]
    s_waitcnt lgkmcnt(1)
    v_mfma_f32_32x32x16_bf16 v[128:143], v[224:227], a[120:123], v[128:143]
    s_waitcnt lgkmcnt(0)
    v_mfma_f32_32x32x16_bf16 v[128:143], v[228:231], a[124:127], v[128:143]
    s_cmp_lg_u32 s94, 0
    s_cbranch_scc1 fused_kernel_P4
    s_waitcnt vmcnt(6)
    s_barrier
    v_add_u32 v14, 0, v10
    v_add_u32 v15, 0, v11
    v_add_u32 v16, 0, v12
    v_add_u32 v17, 0, v13
    ds_read_b128 v[200:203], v14 offset:0
    ds_read_b128 v[204:207], v15 offset:0
    ds_read_b128 v[208:211], v16 offset:0
    ds_read_b128 v[212:215], v17 offset:0
    ds_read_b128 v[216:219], v14 offset:4096
    ds_read_b128 v[220:223], v15 offset:4096
    s_waitcnt lgkmcnt(5)
    v_mfma_f32_32x32x16_bf16 v[144:159], v[200:203], a[0:3], 0
    ds_read_b128 v[224:227], v16 offset:4096
    s_waitcnt lgkmcnt(5)
    v_mfma_f32_32x32x16_bf16 v[144:159], v[204:207], a[4:7], v[144:159]
    ds_read_b128 v[228:231], v17 offset:4096
    s_add_u32 s35, s38, 96
    s_lshr_b32 s36, s35, 9
    s_waitcnt lgkmcnt(5)
    v_mfma_f32_32x32x16_bf16 v[144:159], v[208:211], a[8:11], v[144:159]
    ds_read_b128 v[200:203], v14 offset:8192
    s_and_b32 s35, s35, 511
    s_lshr_b32 s35, s35, 4
    s_waitcnt lgkmcnt(5)
    v_mfma_f32_32x32x16_bf16 v[144:159], v[212:215], a[12:15], v[144:159]
    ds_read_b128 v[204:207], v15 offset:8192
    s_mul_i32 s35, s35, 10
    s_add_u32 s35, s35, s36
    s_waitcnt lgkmcnt(5)
    v_mfma_f32_32x32x16_bf16 v[144:159], v[216:219], a[16:19], v[144:159]
    ds_read_b128 v[208:211], v16 offset:8192
    s_lshl_b32 s35, s35, 10
    s_add_u32 s36, s35, 10240
    s_waitcnt lgkmcnt(5)
    v_mfma_f32_32x32x16_bf16 v[144:159], v[220:223], a[20:23], v[144:159]
    ds_read_b128 v[212:215], v17 offset:8192
    v_cvt_pk_bf16_f32 v184, v128, v129
    v_cvt_pk_bf16_f32 v185, v130, v131
    s_waitcnt lgkmcnt(5)
    v_mfma_f32_32x32x16_bf16 v[144:159], v[224:227], a[24:27], v[144:159]
    ds_read_b128 v[216:219], v14 offset:12288
    v_cvt_pk_bf16_f32 v186, v132, v133
    v_cvt_pk_bf16_f32 v187, v134, v135
    s_waitcnt lgkmcnt(5)
    v_mfma_f32_32x32x16_bf16 v[144:159], v[228:231], a[28:31], v[144:159]
    ds_read_b128 v[220:223], v15 offset:12288
    buffer_store_dwordx4 v[184:187], v19, s[20:23], s35 offen sc1
    v_cvt_pk_bf16_f32 v188, v136, v137
    s_waitcnt lgkmcnt(5)
    v_mfma_f32_32x32x16_bf16 v[144:159], v[200:203], a[32:35], v[144:159]
    ds_read_b128 v[224:227], v16 offset:12288
    v_cvt_pk_bf16_f32 v189, v138, v139
    v_cvt_pk_bf16_f32 v190, v140, v141
    s_waitcnt lgkmcnt(5)
    v_mfma_f32_32x32x16_bf16 v[144:159], v[204:207], a[36:39], v[144:159]
    ds_read_b128 v[228:231], v17 offset:12288
    v_cvt_pk_bf16_f32 v191, v142, v143
    buffer_store_dwordx4 v[188:191], v19, s[20:23], s36 offen sc1
    s_waitcnt lgkmcnt(5)
    v_mfma_f32_32x32x16_bf16 v[144:159], v[208:211], a[40:43], v[144:159]
    ds_read_b128 v[200:203], v14 offset:16384
    s_waitcnt lgkmcnt(5)
    v_mfma_f32_32x32x16_bf16 v[144:159], v[212:215], a[44:47], v[144:159]
    ds_read_b128 v[204:207], v15 offset:16384
    s_waitcnt lgkmcnt(5)
    v_mfma_f32_32x32x16_bf16 v[144:159], v[216:219], a[48:51], v[144:159]
    ds_read_b128 v[208:211], v16 offset:16384
    s_waitcnt lgkmcnt(5)
    v_mfma_f32_32x32x16_bf16 v[144:159], v[220:223], a[52:55], v[144:159]
    ds_read_b128 v[212:215], v17 offset:16384
    s_waitcnt lgkmcnt(5)
    v_mfma_f32_32x32x16_bf16 v[144:159], v[224:227], a[56:59], v[144:159]
    ds_read_b128 v[216:219], v14 offset:20480
    s_waitcnt lgkmcnt(5)
    v_mfma_f32_32x32x16_bf16 v[144:159], v[228:231], a[60:63], v[144:159]
    ds_read_b128 v[220:223], v15 offset:20480
    s_waitcnt lgkmcnt(5)
    v_mfma_f32_32x32x16_bf16 v[144:159], v[200:203], a[64:67], v[144:159]
    ds_read_b128 v[224:227], v16 offset:20480
    s_waitcnt lgkmcnt(5)
    v_mfma_f32_32x32x16_bf16 v[144:159], v[204:207], a[68:71], v[144:159]
    ds_read_b128 v[228:231], v17 offset:20480
    s_waitcnt lgkmcnt(5)
    v_mfma_f32_32x32x16_bf16 v[144:159], v[208:211], a[72:75], v[144:159]
    ds_read_b128 v[200:203], v14 offset:24576
    s_waitcnt lgkmcnt(5)
    v_mfma_f32_32x32x16_bf16 v[144:159], v[212:215], a[76:79], v[144:159]
    ds_read_b128 v[204:207], v15 offset:24576
    s_waitcnt lgkmcnt(5)
    v_mfma_f32_32x32x16_bf16 v[144:159], v[216:219], a[80:83], v[144:159]
    ds_read_b128 v[208:211], v16 offset:24576
    s_waitcnt lgkmcnt(5)
    v_mfma_f32_32x32x16_bf16 v[144:159], v[220:223], a[84:87], v[144:159]
    ds_read_b128 v[212:215], v17 offset:24576
    s_waitcnt lgkmcnt(5)
    v_mfma_f32_32x32x16_bf16 v[144:159], v[224:227], a[88:91], v[144:159]
    ds_read_b128 v[216:219], v14 offset:28672
    s_waitcnt lgkmcnt(5)
    v_mfma_f32_32x32x16_bf16 v[144:159], v[228:231], a[92:95], v[144:159]
    ds_read_b128 v[220:223], v15 offset:28672
    s_waitcnt lgkmcnt(5)
    v_mfma_f32_32x32x16_bf16 v[144:159], v[200:203], a[96:99], v[144:159]
    ds_read_b128 v[224:227], v16 offset:28672
    s_waitcnt lgkmcnt(5)
    v_mfma_f32_32x32x16_bf16 v[144:159], v[204:207], a[100:103], v[144:159]
    ds_read_b128 v[228:231], v17 offset:28672
    s_waitcnt lgkmcnt(5)
    v_mfma_f32_32x32x16_bf16 v[144:159], v[208:211], a[104:107], v[144:159]
    s_waitcnt lgkmcnt(4)
    v_mfma_f32_32x32x16_bf16 v[144:159], v[212:215], a[108:111], v[144:159]
    s_waitcnt lgkmcnt(3)
    v_mfma_f32_32x32x16_bf16 v[144:159], v[216:219], a[112:115], v[144:159]
    s_waitcnt lgkmcnt(2)
    v_mfma_f32_32x32x16_bf16 v[144:159], v[220:223], a[116:119], v[144:159]
    s_waitcnt lgkmcnt(1)
    v_mfma_f32_32x32x16_bf16 v[144:159], v[224:227], a[120:123], v[144:159]
    s_waitcnt lgkmcnt(0)
    v_mfma_f32_32x32x16_bf16 v[144:159], v[228:231], a[124:127], v[144:159]
    s_nop 3
    s_add_u32 s35, s38, 128
    s_lshr_b32 s36, s35, 9
    s_and_b32 s35, s35, 511
    s_lshr_b32 s35, s35, 4
    s_mul_i32 s35, s35, 10
    s_add_u32 s35, s35, s36
    s_lshl_b32 s35, s35, 10
    s_add_u32 s36, s35, 10240
    v_cvt_pk_bf16_f32 v192, v144, v145
    v_cvt_pk_bf16_f32 v193, v146, v147
    v_cvt_pk_bf16_f32 v194, v148, v149
    v_cvt_pk_bf16_f32 v195, v150, v151
    buffer_store_dwordx4 v[192:195], v19, s[20:23], s35 offen sc1
    v_cvt_pk_bf16_f32 v196, v152, v153
    v_cvt_pk_bf16_f32 v197, v154, v155
    v_cvt_pk_bf16_f32 v198, v156, v157
    v_cvt_pk_bf16_f32 v199, v158, v159
    buffer_store_dwordx4 v[196:199], v19, s[20:23], s36 offen sc1
    s_branch fused_kernel_Pdone
fused_kernel_P4:
    s_lshr_b32 s35, s34, 1
    s_and_b32 s37, s35, 1
    s_mul_i32 s35, s35, 20480
    s_add_u32 s35, s35, 9216
    s_add_u32 s36, s35, 10240
    s_cmp_eq_u32 s37, 0
    s_cbranch_scc0 fused_kernel_rp1
    buffer_store_dwordx4 a[0:3], v19, s[20:23], s35 offen sc1
    buffer_store_dwordx4 a[4:7], v19, s[20:23], s36 offen sc1
    s_branch fused_kernel_rp2
fused_kernel_rp1:
    buffer_store_dwordx4 a[8:11], v19, s[20:23], s35 offen sc1
    buffer_store_dwordx4 a[12:15], v19, s[20:23], s36 offen sc1
fused_kernel_rp2:
    s_nop 3
    s_add_u32 s35, s38, 96
    s_lshr_b32 s36, s35, 9
    s_and_b32 s35, s35, 511
    s_lshr_b32 s35, s35, 4
    s_mul_i32 s35, s35, 10
    s_add_u32 s35, s35, s36
    s_lshl_b32 s35, s35, 10
    s_add_u32 s36, s35, 10240
    v_cvt_pk_bf16_f32 v184, v128, v129
    v_cvt_pk_bf16_f32 v185, v130, v131
    v_cvt_pk_bf16_f32 v186, v132, v133
    v_cvt_pk_bf16_f32 v187, v134, v135
    buffer_store_dwordx4 v[184:187], v19, s[20:23], s35 offen sc1
    v_cvt_pk_bf16_f32 v188, v136, v137
    v_cvt_pk_bf16_f32 v189, v138, v139
    v_cvt_pk_bf16_f32 v190, v140, v141
    v_cvt_pk_bf16_f32 v191, v142, v143
    buffer_store_dwordx4 v[188:191], v19, s[20:23], s36 offen sc1
fused_kernel_Pdone:
    s_mov_b32 s37, 0
fused_kernel_ncpollP:
    v_readfirstlane_b32 s3, v21
    s_add_u32 s37, s37, 1
    s_cmp_gt_u32 s37, 100000
    s_cbranch_scc1 fused_kernel_ncokP
    s_cmp_lg_u32 s3, 0
    s_cbranch_scc1 fused_kernel_ncokP
    buffer_load_dword v21, v22, s[28:31], 0 offen sc1
    s_waitcnt vmcnt(0)
    s_branch fused_kernel_ncpollP
fused_kernel_ncokP:
    v_lshrrev_b32 v2, 2, v1
    v_lshlrev_b32 v2, 4, v2
    v_and_b32 v3, 3, v1
    v_add_u32 v2, v2, v3
    v_mul_u32_u24 v2, 1024, v2
    s_add_u32 s36, s34, 16
    s_and_b32 s92, s36, 7
    s_lshl_b32 s92, s92, 7
    s_lshr_b32 s36, s36, 3
    s_lshl_b32 s36, s36, 2
    s_add_u32 s36, s36, s92
    s_mul_i32 s35, s33, 4096
    s_add_u32 s35, s35, s36
    s_add_u32 s35, s35, 11534336
    s_mov_b64 s[92:93], -1
    s_waitcnt vmcnt(0)
    s_barrier
    s_cmp_lg_u32 s32, 0
    s_cbranch_scc1 fused_kernel_ph2
    s_mov_b64 exec, s[92:93]
    buffer_store_dword v21, v2, s[20:23], s35 offen sc1
    s_mov_b64 exec, -1
    s_branch fused_kernel_ph2
fused_kernel_ph2:
    s_and_b32 s38, s2, 7
    s_lshr_b32 s39, s2, 3
    s_and_b32 s37, s38, 1
    s_lshr_b32 s38, s38, 1
    s_and_b32 s35, s39, 7
    s_lshr_b32 s39, s39, 3
    s_lshl_b32 s36, s38, 2
    s_add_u32 s36, s36, s39
    s_lshl_b32 s38, s37, 5
    s_lshl_b32 s39, s35, 2
    s_add_u32 s97, s38, s39
    s_mov_b32 s28, s50
    s_and_b32 s29, s51, 0xffff
    s_mov_b32 s30, 0x1000000
    s_mov_b32 s31, 0x00020000
    s_lshr_b32 s38, s97, 2
    s_lshl_b32 s38, s38, 4
    s_add_u32 s38, s38, s36
    s_mul_i32 s38, s38, 1024
    s_add_u32 s38, s38, 11534336
    v_and_b32 v192, 7, v1
    v_lshlrev_b32 v192, 7, v192
    v_lshrrev_b32 v193, 3, v1
    v_lshl_add_u32 v192, v193, 2, v192
    v_add_u32 v192, s38, v192
    s_movk_i32 s33, 0x1000
    s_movk_i32 s34, 0x2000
    s_mov_b32 s42, 0x200000
    s_mov_b32 s43, 0x201000
    s_lshl_b32 s96, s97, 15
    s_lshl_b32 s38, s32, 13
    s_add_u32 s96, s96, s38
    v_lshlrev_b32 v2, 4, v1
    s_add_u32 s38, s96, 0
    v_add_u32 v9, s38, v2
    s_add_u32 s38, s96, 32768
    v_add_u32 v10, s38, v2
    s_add_u32 s38, s96, 65536
    v_add_u32 v11, s38, v2
    s_add_u32 s38, s96, 98304
    v_add_u32 v12, s38, v2
    s_sub_u32 s38, s96, 32768
    s_cmp_eq_u32 s35, 0
    s_cselect_b32 s38, 0x40000000, s38
    v_add_u32 v8, s38, v2
    s_add_u32 s38, s96, 131072
    s_cmp_eq_u32 s35, 7
    s_cselect_b32 s38, 0x40000000, s38
    v_add_u32 v13, s38, v2
    s_lshl_b32 s38, s36, 5
    s_lshl_b32 s39, s32, 3
    s_add_u32 s38, s38, s39
    s_mul_i32 s92, s38, 10240
    v_add_u32 v3, s92, v2
    s_mov_b32 s12, s50
    s_and_b32 s13, s51, 0xffff
    s_mov_b32 s14, 0x400000
    s_mov_b32 s15, 0x00020000
    s_add_u32 s16, s50, 0x400000
    s_addc_u32 s17, s51, 0
    s_and_b32 s17, s17, 0xffff
    s_mov_b32 s18, 0x500000
    s_mov_b32 s19, 0x00020000
    s_mov_b32 s20, s40
    s_and_b32 s21, s41, 0xffff
    s_mov_b32 s22, 0x200000
    s_mov_b32 s23, 0x00020000
    s_mov_b32 s24, s46
    s_and_b32 s25, s47, 0xffff
    s_mov_b32 s26, 0x200000
    s_mov_b32 s27, 0x00020000
    s_add_u32 s38, s97, s32
    s_lshl_b32 s38, s38, 15
    s_lshl_b32 s39, s36, 6
    s_add_u32 s38, s38, s39
    v_lshrrev_b32 v6, 2, v1
    v_lshlrev_b32 v6, 10, v6
    v_and_b32 v7, 3, v1
    v_lshlrev_b32 v7, 4, v7
    v_add3_u32 v6, v6, v7, s38
    s_movk_i32 s39, 0x4000
    v_and_b32 v2, 31, v1
    v_cmp_ne_u32 vcc, 0, v2
    s_nop 1
    v_cndmask_b32 v4, 0, -1, vcc
    v_cmp_ne_u32 vcc, 31, v2
    s_nop 1
    v_cndmask_b32 v5, 0, -1, vcc
    v_lshlrev_b32 v14, 4, v1
    s_mul_i32 s38, s32, 4352
    v_add_u32 v14, s38, v14
    v_and_b32 v15, 3, v1
    v_mul_u32_u24 v15, 1088, v15
    v_lshrrev_b32 v2, 2, v1
    v_lshl_add_u32 v15, v2, 4, v15
    s_mul_i32 s38, s32, 17408
    v_add_u32 v15, s38, v15
    s_mov_b32 s90, 0xffff0000
    s_mov_b32 s91, 0xffff
    s_movk_i32 s38, 0x1111
    s_cmp_eq_u32 s35, 0
    s_cselect_b32 s38, 0x1110, s38
    s_cmp_eq_u32 s35, 7
    s_cselect_b32 s38, 0x0111, s38
    s_lshl_b32 s94, s38, s32
    s_mov_b32 s95, 0
    s_mov_b32 s38, 0xffff
    s_cmp_eq_u32 s35, 0
    s_cselect_b32 s38, 0xfff0, s38
    s_cmp_eq_u32 s35, 7
    s_cselect_b32 s94, 0x0fff, s38
    s_or_b64 s[90:91], s[90:91], s[94:95]
    s_cmp_lg_u32 s32, 0
    s_cbranch_scc1 fused_kernel_fwP
    s_mov_b32 s38, 0
fused_kernel_fpollP:
    buffer_load_dword v193, v192, s[28:31], 0 offen sc1
fused_kernel_fchkP:
    s_add_u32 s38, s38, 1
    s_cmp_gt_u32 s38, 200000
    s_cbranch_scc1 fused_kernel_fwP
    s_waitcnt vmcnt(0)
    v_cmp_ne_u32 vcc, s3, v193
    s_nop 4
    s_and_b64 vcc, vcc, s[90:91]
    s_cbranch_scc1 fused_kernel_fpollP
fused_kernel_fwP:
    s_waitcnt vmcnt(0)
    s_barrier
    s_mov_b32 s38, 0
    buffer_load_dwordx4 a[68:71], v3, s[16:19], s38 offen offset:1024 sc1
    buffer_load_dwordx4 v[24:27], v8, s[12:15], 0 offen offset:0 sc1
    buffer_load_dwordx4 v[28:31], v9, s[12:15], 0 offen offset:0 sc1
    buffer_load_dwordx4 v[32:35], v10, s[12:15], 0 offen offset:0 sc1
    buffer_load_dwordx4 v[36:39], v11, s[12:15], 0 offen offset:0 sc1
    s_mov_b32 s38, 4096
    buffer_load_dwordx4 a[80:83], v3, s[16:19], s38 offen offset:0 sc1
    buffer_load_dwordx4 v[40:43], v12, s[12:15], 0 offen offset:0 sc1
    s_mov_b32 s38, 4096
    buffer_load_dwordx4 a[92:95], v3, s[16:19], s38 offen offset:3072 sc1
    buffer_load_dwordx4 v[44:47], v13, s[12:15], 0 offen offset:0 sc1
    s_mov_b32 s38, 8192
    buffer_load_dwordx4 a[100:103], v3, s[16:19], s38 offen offset:1024 sc1
    buffer_load_dwordx4 v[96:99], v9, s[12:15], s42 offen offset:0 sc1
    buffer_load_dwordx4 v[100:103], v10, s[12:15], s42 offen offset:0 sc1
    buffer_load_dwordx4 v[104:107], v11, s[12:15], s42 offen offset:0 sc1
    buffer_load_dwordx4 v[108:111], v12, s[12:15], s42 offen offset:0 sc1
    s_waitcnt vmcnt(12)
    v_mfma_f32_32x32x16_bf16 a[0:15], a[68:71], v[24:27], 0
    s_mov_b32 s38, 0
    buffer_load_dwordx4 a[64:67], v3, s[16:19], s38 offen offset:0 sc1
    s_waitcnt vmcnt(12)
    v_mfma_f32_32x32x16_bf16 a[16:31], a[68:71], v[28:31], 0
    s_waitcnt vmcnt(11)
    v_mfma_f32_32x32x16_bf16 a[32:47], a[68:71], v[32:35], 0
    v_and_b32_dpp v144, v24, v4 wave_shr:1 row_mask:0xf bank_mask:0xf bound_ctrl:0
    v_and_b32_dpp v145, v25, v4 wave_shr:1 row_mask:0xf bank_mask:0xf bound_ctrl:0
    s_mov_b32 s38, 0
    buffer_load_dwordx4 a[76:79], v3, s[16:19], s38 offen offset:3072 sc1
    s_waitcnt vmcnt(11)
    v_mfma_f32_32x32x16_bf16 a[48:63], a[68:71], v[36:39], 0
    v_and_b32_dpp v146, v26, v4 wave_shr:1 row_mask:0xf bank_mask:0xf bound_ctrl:0
    v_and_b32_dpp v147, v27, v4 wave_shr:1 row_mask:0xf bank_mask:0xf bound_ctrl:0
    s_waitcnt vmcnt(10)
    v_mfma_f32_32x32x16_bf16 a[0:15], a[80:83], v[28:31], a[0:15]
    v_and_b32_dpp v148, v28, v4 wave_shr:1 row_mask:0xf bank_mask:0xf bound_ctrl:0
    v_and_b32_dpp v149, v29, v4 wave_shr:1 row_mask:0xf bank_mask:0xf bound_ctrl:0
    s_mov_b32 s38, 4096
    buffer_load_dwordx4 a[88:91], v3, s[16:19], s38 offen offset:2048 sc1
    v_mfma_f32_32x32x16_bf16 a[16:31], a[80:83], v[32:35], a[16:31]
    v_and_b32_dpp v150, v30, v4 wave_shr:1 row_mask:0xf bank_mask:0xf bound_ctrl:0
    v_and_b32_dpp v151, v31, v4 wave_shr:1 row_mask:0xf bank_mask:0xf bound_ctrl:0
    v_mfma_f32_32x32x16_bf16 a[32:47], a[80:83], v[36:39], a[32:47]
    v_and_b32_dpp v152, v32, v4 wave_shr:1 row_mask:0xf bank_mask:0xf bound_ctrl:0
    v_and_b32_dpp v153, v33, v4 wave_shr:1 row_mask:0xf bank_mask:0xf bound_ctrl:0
    s_mov_b32 s38, 0
    buffer_load_dwordx4 a[72:75], v3, s[16:19], s38 offen offset:2048 sc1
    s_waitcnt vmcnt(11)
    v_mfma_f32_32x32x16_bf16 a[48:63], a[80:83], v[40:43], a[48:63]
    v_and_b32_dpp v154, v34, v4 wave_shr:1 row_mask:0xf bank_mask:0xf bound_ctrl:0
    v_and_b32_dpp v155, v35, v4 wave_shr:1 row_mask:0xf bank_mask:0xf bound_ctrl:0
    s_waitcnt vmcnt(10)
    v_mfma_f32_32x32x16_bf16 a[0:15], a[92:95], v[32:35], a[0:15]
    v_and_b32_dpp v156, v36, v4 wave_shr:1 row_mask:0xf bank_mask:0xf bound_ctrl:0
    v_and_b32_dpp v157, v37, v4 wave_shr:1 row_mask:0xf bank_mask:0xf bound_ctrl:0
    s_mov_b32 s38, 4096
    buffer_load_dwordx4 a[84:87], v3, s[16:19], s38 offen offset:1024 sc1
    v_mfma_f32_32x32x16_bf16 a[16:31], a[92:95], v[36:39], a[16:31]
    v_and_b32_dpp v158, v38, v4 wave_shr:1 row_mask:0xf bank_mask:0xf bound_ctrl:0
    v_and_b32_dpp v159, v39, v4 wave_shr:1 row_mask:0xf bank_mask:0xf bound_ctrl:0
    v_mfma_f32_32x32x16_bf16 a[32:47], a[92:95], v[40:43], a[32:47]
    v_and_b32_dpp v160, v40, v4 wave_shr:1 row_mask:0xf bank_mask:0xf bound_ctrl:0
    v_and_b32_dpp v161, v41, v4 wave_shr:1 row_mask:0xf bank_mask:0xf bound_ctrl:0
    s_mov_b32 s38, 8192
    buffer_load_dwordx4 a[96:99], v3, s[16:19], s38 offen offset:0 sc1
    s_waitcnt vmcnt(11)
    v_mfma_f32_32x32x16_bf16 a[48:63], a[92:95], v[44:47], a[48:63]
    v_and_b32_dpp v162, v42, v4 wave_shr:1 row_mask:0xf bank_mask:0xf bound_ctrl:0
    v_and_b32_dpp v163, v43, v4 wave_shr:1 row_mask:0xf bank_mask:0xf bound_ctrl:0
    s_mov_b32 s38, 8192
    buffer_load_dwordx4 a[108:111], v3, s[16:19], s38 offen offset:3072 sc1
    s_waitcnt vmcnt(10)
    v_mfma_f32_32x32x16_bf16 a[0:15], a[100:103], v[96:99], a[0:15]
    v_and_b32_dpp v164, v44, v4 wave_shr:1 row_mask:0xf bank_mask:0xf bound_ctrl:0
    v_and_b32_dpp v165, v45, v4 wave_shr:1 row_mask:0xf bank_mask:0xf bound_ctrl:0
    s_waitcnt vmcnt(9)
    v_mfma_f32_32x32x16_bf16 a[16:31], a[100:103], v[100:103], a[16:31]
    v_and_b32_dpp v166, v46, v4 wave_shr:1 row_mask:0xf bank_mask:0xf bound_ctrl:0
    v_and_b32_dpp v167, v47, v4 wave_shr:1 row_mask:0xf bank_mask:0xf bound_ctrl:0
    buffer_load_dwordx4 v[48:51], v8, s[12:15], 0 offen offset:1024 sc1
    s_waitcnt vmcnt(9)
    v_mfma_f32_32x32x16_bf16 a[32:47], a[100:103], v[104:107], a[32:47]
    s_waitcnt vmcnt(8)
    v_mfma_f32_32x32x16_bf16 a[48:63], a[100:103], v[108:111], a[48:63]
    buffer_load_dwordx4 v[52:55], v9, s[12:15], 0 offen offset:1024 sc1
    s_waitcnt vmcnt(8)
    v_mfma_f32_32x32x16_bf16 a[0:15], a[64:67], v[144:147], a[0:15]
    v_and_b32_dpp v168, v24, v5 wave_shl:1 row_mask:0xf bank_mask:0xf bound_ctrl:0
    v_and_b32_dpp v169, v25, v5 wave_shl:1 row_mask:0xf bank_mask:0xf bound_ctrl:0
    v_and_b32_dpp v170, v26, v5 wave_shl:1 row_mask:0xf bank_mask:0xf bound_ctrl:0
    v_mfma_f32_32x32x16_bf16 a[16:31], a[64:67], v[148:151], a[16:31]
    v_and_b32_dpp v171, v27, v5 wave_shl:1 row_mask:0xf bank_mask:0xf bound_ctrl:0
    v_and_b32_dpp v172, v28, v5 wave_shl:1 row_mask:0xf bank_mask:0xf bound_ctrl:0
    v_and_b32_dpp v173, v29, v5 wave_shl:1 row_mask:0xf bank_mask:0xf bound_ctrl:0
    buffer_load_dwordx4 v[56:59], v10, s[12:15], 0 offen offset:1024 sc1
    v_mfma_f32_32x32x16_bf16 a[32:47], a[64:67], v[152:155], a[32:47]
    v_and_b32_dpp v174, v30, v5 wave_shl:1 row_mask:0xf bank_mask:0xf bound_ctrl:0
    v_and_b32_dpp v175, v31, v5 wave_shl:1 row_mask:0xf bank_mask:0xf bound_ctrl:0
    v_and_b32_dpp v176, v32, v5 wave_shl:1 row_mask:0xf bank_mask:0xf bound_ctrl:0
    v_mfma_f32_32x32x16_bf16 a[48:63], a[64:67], v[156:159], a[48:63]
    v_and_b32_dpp v177, v33, v5 wave_shl:1 row_mask:0xf bank_mask:0xf bound_ctrl:0
    v_and_b32_dpp v178, v34, v5 wave_shl:1 row_mask:0xf bank_mask:0xf bound_ctrl:0
    v_and_b32_dpp v179, v35, v5 wave_shl:1 row_mask:0xf bank_mask:0xf bound_ctrl:0
    buffer_load_dwordx4 v[60:63], v11, s[12:15], 0 offen offset:1024 sc1
    s_waitcnt vmcnt(9)
    v_mfma_f32_32x32x16_bf16 a[0:15], a[76:79], v[148:151], a[0:15]
    v_and_b32_dpp v180, v36, v5 wave_shl:1 row_mask:0xf bank_mask:0xf bound_ctrl:0
    v_and_b32_dpp v181, v37, v5 wave_shl:1 row_mask:0xf bank_mask:0xf bound_ctrl:0
    v_and_b32_dpp v182, v38, v5 wave_shl:1 row_mask:0xf bank_mask:0xf bound_ctrl:0
    s_mov_b32 s38, 12288
    buffer_load_dwordx4 a[120:123], v3, s[16:19], s38 offen offset:2048 sc1
    v_mfma_f32_32x32x16_bf16 a[16:31], a[76:79], v[152:155], a[16:31]
    v_and_b32_dpp v183, v39, v5 wave_shl:1 row_mask:0xf bank_mask:0xf bound_ctrl:0
    v_and_b32_dpp v184, v40, v5 wave_shl:1 row_mask:0xf bank_mask:0xf bound_ctrl:0
    v_and_b32_dpp v185, v41, v5 wave_shl:1 row_mask:0xf bank_mask:0xf bound_ctrl:0
    v_mfma_f32_32x32x16_bf16 a[32:47], a[76:79], v[156:159], a[32:47]
    v_and_b32_dpp v186, v42, v5 wave_shl:1 row_mask:0xf bank_mask:0xf bound_ctrl:0
    v_and_b32_dpp v187, v43, v5 wave_shl:1 row_mask:0xf bank_mask:0xf bound_ctrl:0
    v_and_b32_dpp v188, v44, v5 wave_shl:1 row_mask:0xf bank_mask:0xf bound_ctrl:0
    buffer_load_dwordx4 v[64:67], v12, s[12:15], 0 offen offset:1024 sc1
    v_mfma_f32_32x32x16_bf16 a[48:63], a[76:79], v[160:163], a[48:63]
    v_and_b32_dpp v189, v45, v5 wave_shl:1 row_mask:0xf bank_mask:0xf bound_ctrl:0
    v_and_b32_dpp v190, v46, v5 wave_shl:1 row_mask:0xf bank_mask:0xf bound_ctrl:0
    v_and_b32_dpp v191, v47, v5 wave_shl:1 row_mask:0xf bank_mask:0xf bound_ctrl:0
    s_waitcnt vmcnt(10)
    v_mfma_f32_32x32x16_bf16 a[0:15], a[88:91], v[152:155], a[0:15]
    s_mov_b32 s38, 16384
    buffer_load_dwordx4 a[132:135], v3, s[16:19], s38 offen offset:1024 sc1
    v_mfma_f32_32x32x16_bf16 a[16:31], a[88:91], v[156:159], a[16:31]
    v_mfma_f32_32x32x16_bf16 a[32:47], a[88:91], v[160:163], a[32:47]
    buffer_load_dwordx4 v[68:71], v13, s[12:15], 0 offen offset:1024 sc1
    v_mfma_f32_32x32x16_bf16 a[48:63], a[88:91], v[164:167], a[48:63]
    s_waitcnt vmcnt(11)
    v_mfma_f32_32x32x16_bf16 a[0:15], a[72:75], v[168:171], a[0:15]
    s_mov_b32 s38, 16384
    buffer_load_dwordx4 a[140:143], v3, s[16:19], s38 offen offset:3072 sc1
    v_mfma_f32_32x32x16_bf16 a[16:31], a[72:75], v[172:175], a[16:31]
    v_mfma_f32_32x32x16_bf16 a[32:47], a[72:75], v[176:179], a[32:47]
    buffer_load_dwordx4 v[112:115], v9, s[12:15], s42 offen offset:1024 sc1
    v_mfma_f32_32x32x16_bf16 a[48:63], a[72:75], v[180:183], a[48:63]
    buffer_load_dwordx4 v[116:119], v10, s[12:15], s42 offen offset:1024 sc1
    s_waitcnt vmcnt(13)
    v_mfma_f32_32x32x16_bf16 a[0:15], a[84:87], v[172:175], a[0:15]
    v_mfma_f32_32x32x16_bf16 a[16:31], a[84:87], v[176:179], a[16:31]
    buffer_load_dwordx4 v[120:123], v11, s[12:15], s42 offen offset:1024 sc1
    v_mfma_f32_32x32x16_bf16 a[32:47], a[84:87], v[180:183], a[32:47]
    v_mfma_f32_32x32x16_bf16 a[48:63], a[84:87], v[184:187], a[48:63]
    buffer_load_dwordx4 v[124:127], v12, s[12:15], s42 offen offset:1024 sc1
    s_waitcnt vmcnt(14)
    v_mfma_f32_32x32x16_bf16 a[0:15], a[96:99], v[176:179], a[0:15]
    v_mfma_f32_32x32x16_bf16 a[16:31], a[96:99], v[180:183], a[16:31]
    s_mov_b32 s38, 8192
    buffer_load_dwordx4 a[104:107], v3, s[16:19], s38 offen offset:2048 sc1
    v_mfma_f32_32x32x16_bf16 a[32:47], a[96:99], v[184:187], a[32:47]
    v_mfma_f32_32x32x16_bf16 a[48:63], a[96:99], v[188:191], a[48:63]
    s_mov_b32 s38, 12288
    buffer_load_dwordx4 a[116:119], v3, s[16:19], s38 offen offset:1024 sc1
    s_waitcnt vmcnt(14)
    v_mfma_f32_32x32x16_bf16 a[0:15], a[108:111], v[48:51], a[0:15]
    s_mov_b32 s38, 16384
    buffer_load_dwordx4 a[128:131], v3, s[16:19], s38 offen offset:0 sc1
    s_waitcnt vmcnt(14)
    v_mfma_f32_32x32x16_bf16 a[16:31], a[108:111], v[52:55], a[16:31]
    s_waitcnt vmcnt(13)
    v_mfma_f32_32x32x16_bf16 a[32:47], a[108:111], v[56:59], a[32:47]
    v_and_b32_dpp v144, v48, v4 wave_shr:1 row_mask:0xf bank_mask:0xf bound_ctrl:0
    v_and_b32_dpp v145, v49, v4 wave_shr:1 row_mask:0xf bank_mask:0xf bound_ctrl:0
    s_mov_b32 s38, 12288
    buffer_load_dwordx4 a[112:115], v3, s[16:19], s38 offen offset:0 sc1
    s_waitcnt vmcnt(13)
    v_mfma_f32_32x32x16_bf16 a[48:63], a[108:111], v[60:63], a[48:63]
    v_and_b32_dpp v146, v50, v4 wave_shr:1 row_mask:0xf bank_mask:0xf bound_ctrl:0
    v_and_b32_dpp v147, v51, v4 wave_shr:1 row_mask:0xf bank_mask:0xf bound_ctrl:0
    s_waitcnt vmcnt(12)
    v_mfma_f32_32x32x16_bf16 a[0:15], a[120:123], v[52:55], a[0:15]
    v_and_b32_dpp v148, v52, v4 wave_shr:1 row_mask:0xf bank_mask:0xf bound_ctrl:0
    v_and_b32_dpp v149, v53, v4 wave_shr:1 row_mask:0xf bank_mask:0xf bound_ctrl:0
    s_mov_b32 s38, 12288
    buffer_load_dwordx4 a[124:127], v3, s[16:19], s38 offen offset:3072 sc1
    v_mfma_f32_32x32x16_bf16 a[16:31], a[120:123], v[56:59], a[16:31]
    v_and_b32_dpp v150, v54, v4 wave_shr:1 row_mask:0xf bank_mask:0xf bound_ctrl:0
    v_and_b32_dpp v151, v55, v4 wave_shr:1 row_mask:0xf bank_mask:0xf bound_ctrl:0
    v_mfma_f32_32x32x16_bf16 a[32:47], a[120:123], v[60:63], a[32:47]
    v_and_b32_dpp v152, v56, v4 wave_shr:1 row_mask:0xf bank_mask:0xf bound_ctrl:0
    v_and_b32_dpp v153, v57, v4 wave_shr:1 row_mask:0xf bank_mask:0xf bound_ctrl:0
    s_mov_b32 s38, 16384
    buffer_load_dwordx4 a[136:139], v3, s[16:19], s38 offen offset:2048 sc1
    s_waitcnt vmcnt(13)
    v_mfma_f32_32x32x16_bf16 a[48:63], a[120:123], v[64:67], a[48:63]
    v_and_b32_dpp v154, v58, v4 wave_shr:1 row_mask:0xf bank_mask:0xf bound_ctrl:0
    v_and_b32_dpp v155, v59, v4 wave_shr:1 row_mask:0xf bank_mask:0xf bound_ctrl:0
    s_waitcnt vmcnt(12)
    v_mfma_f32_32x32x16_bf16 a[0:15], a[132:135], v[56:59], a[0:15]
    v_and_b32_dpp v156, v60, v4 wave_shr:1 row_mask:0xf bank_mask:0xf bound_ctrl:0
    v_and_b32_dpp v157, v61, v4 wave_shr:1 row_mask:0xf bank_mask:0xf bound_ctrl:0
    s_mov_b32 s38, 20480
    buffer_load_dwordx4 a[148:151], v3, s[16:19], s38 offen offset:1024 sc1
    v_mfma_f32_32x32x16_bf16 a[16:31], a[132:135], v[60:63], a[16:31]
    v_and_b32_dpp v158, v62, v4 wave_shr:1 row_mask:0xf bank_mask:0xf bound_ctrl:0
    v_and_b32_dpp v159, v63, v4 wave_shr:1 row_mask:0xf bank_mask:0xf bound_ctrl:0
    v_mfma_f32_32x32x16_bf16 a[32:47], a[132:135], v[64:67], a[32:47]
    v_and_b32_dpp v160, v64, v4 wave_shr:1 row_mask:0xf bank_mask:0xf bound_ctrl:0
    v_and_b32_dpp v161, v65, v4 wave_shr:1 row_mask:0xf bank_mask:0xf bound_ctrl:0
    buffer_load_dwordx4 v[72:75], v8, s[12:15], 0 offen offset:2048 sc1
    s_waitcnt vmcnt(13)
    v_mfma_f32_32x32x16_bf16 a[48:63], a[132:135], v[68:71], a[48:63]
    v_and_b32_dpp v162, v66, v4 wave_shr:1 row_mask:0xf bank_mask:0xf bound_ctrl:0
    v_and_b32_dpp v163, v67, v4 wave_shr:1 row_mask:0xf bank_mask:0xf bound_ctrl:0
    buffer_load_dwordx4 v[76:79], v9, s[12:15], 0 offen offset:2048 sc1
    s_waitcnt vmcnt(12)
    v_mfma_f32_32x32x16_bf16 a[0:15], a[140:143], v[112:115], a[0:15]
    v_and_b32_dpp v164, v68, v4 wave_shr:1 row_mask:0xf bank_mask:0xf bound_ctrl:0
    v_and_b32_dpp v165, v69, v4 wave_shr:1 row_mask:0xf bank_mask:0xf bound_ctrl:0
    s_waitcnt vmcnt(11)
    v_mfma_f32_32x32x16_bf16 a[16:31], a[140:143], v[116:119], a[16:31]
    v_and_b32_dpp v166, v70, v4 wave_shr:1 row_mask:0xf bank_mask:0xf bound_ctrl:0
    v_and_b32_dpp v167, v71, v4 wave_shr:1 row_mask:0xf bank_mask:0xf bound_ctrl:0
    buffer_load_dwordx4 v[80:83], v10, s[12:15], 0 offen offset:2048 sc1
    s_waitcnt vmcnt(11)
    v_mfma_f32_32x32x16_bf16 a[32:47], a[140:143], v[120:123], a[32:47]
    s_waitcnt vmcnt(10)
    v_mfma_f32_32x32x16_bf16 a[48:63], a[140:143], v[124:127], a[48:63]
    buffer_load_dwordx4 v[84:87], v11, s[12:15], 0 offen offset:2048 sc1
    s_waitcnt vmcnt(10)
    v_mfma_f32_32x32x16_bf16 a[0:15], a[104:107], v[144:147], a[0:15]
    v_and_b32_dpp v168, v48, v5 wave_shl:1 row_mask:0xf bank_mask:0xf bound_ctrl:0
    v_and_b32_dpp v169, v49, v5 wave_shl:1 row_mask:0xf bank_mask:0xf bound_ctrl:0
    v_and_b32_dpp v170, v50, v5 wave_shl:1 row_mask:0xf bank_mask:0xf bound_ctrl:0
    v_mfma_f32_32x32x16_bf16 a[16:31], a[104:107], v[148:151], a[16:31]
    v_and_b32_dpp v171, v51, v5 wave_shl:1 row_mask:0xf bank_mask:0xf bound_ctrl:0
    v_and_b32_dpp v172, v52, v5 wave_shl:1 row_mask:0xf bank_mask:0xf bound_ctrl:0
    v_and_b32_dpp v173, v53, v5 wave_shl:1 row_mask:0xf bank_mask:0xf bound_ctrl:0
    s_mov_b32 s38, 24576
    buffer_load_dwordx4 a[160:163], v3, s[16:19], s38 offen offset:0 sc1
    v_mfma_f32_32x32x16_bf16 a[32:47], a[104:107], v[152:155], a[32:47]
    v_and_b32_dpp v174, v54, v5 wave_shl:1 row_mask:0xf bank_mask:0xf bound_ctrl:0
    v_and_b32_dpp v175, v55, v5 wave_shl:1 row_mask:0xf bank_mask:0xf bound_ctrl:0
    v_and_b32_dpp v176, v56, v5 wave_shl:1 row_mask:0xf bank_mask:0xf bound_ctrl:0
    v_mfma_f32_32x32x16_bf16 a[48:63], a[104:107], v[156:159], a[48:63]
    v_and_b32_dpp v177, v57, v5 wave_shl:1 row_mask:0xf bank_mask:0xf bound_ctrl:0
    v_and_b32_dpp v178, v58, v5 wave_shl:1 row_mask:0xf bank_mask:0xf bound_ctrl:0
    v_and_b32_dpp v179, v59, v5 wave_shl:1 row_mask:0xf bank_mask:0xf bound_ctrl:0
    buffer_load_dwordx4 v[88:91], v12, s[12:15], 0 offen offset:2048 sc1
    s_waitcnt vmcnt(11)
    v_mfma_f32_32x32x16_bf16 a[0:15], a[116:119], v[148:151], a[0:15]
    v_and_b32_dpp v180, v60, v5 wave_shl:1 row_mask:0xf bank_mask:0xf bound_ctrl:0
    v_and_b32_dpp v181, v61, v5 wave_shl:1 row_mask:0xf bank_mask:0xf bound_ctrl:0
    v_and_b32_dpp v182, v62, v5 wave_shl:1 row_mask:0xf bank_mask:0xf bound_ctrl:0
    s_mov_b32 s38, 24576
    buffer_load_dwordx4 a[172:175], v3, s[16:19], s38 offen offset:3072 sc1
    v_mfma_f32_32x32x16_bf16 a[16:31], a[116:119], v[152:155], a[16:31]
    v_and_b32_dpp v183, v63, v5 wave_shl:1 row_mask:0xf bank_mask:0xf bound_ctrl:0
    v_and_b32_dpp v184, v64, v5 wave_shl:1 row_mask:0xf bank_mask:0xf bound_ctrl:0
    v_and_b32_dpp v185, v65, v5 wave_shl:1 row_mask:0xf bank_mask:0xf bound_ctrl:0
    v_mfma_f32_32x32x16_bf16 a[32:47], a[116:119], v[156:159], a[32:47]
    v_and_b32_dpp v186, v66, v5 wave_shl:1 row_mask:0xf bank_mask:0xf bound_ctrl:0
    v_and_b32_dpp v187, v67, v5 wave_shl:1 row_mask:0xf bank_mask:0xf bound_ctrl:0
    v_and_b32_dpp v188, v68, v5 wave_shl:1 row_mask:0xf bank_mask:0xf bound_ctrl:0
    buffer_load_dwordx4 v[92:95], v13, s[12:15], 0 offen offset:2048 sc1
    v_mfma_f32_32x32x16_bf16 a[48:63], a[116:119], v[160:163], a[48:63]
    v_and_b32_dpp v189, v69, v5 wave_shl:1 row_mask:0xf bank_mask:0xf bound_ctrl:0
    v_and_b32_dpp v190, v70, v5 wave_shl:1 row_mask:0xf bank_mask:0xf bound_ctrl:0
    v_and_b32_dpp v191, v71, v5 wave_shl:1 row_mask:0xf bank_mask:0xf bound_ctrl:0
    s_waitcnt vmcnt(12)
    v_mfma_f32_32x32x16_bf16 a[0:15], a[128:131], v[152:155], a[0:15]
    s_mov_b32 s38, 28672
    buffer_load_dwordx4 a[180:183], v3, s[16:19], s38 offen offset:1024 sc1
    v_mfma_f32_32x32x16_bf16 a[16:31], a[128:131], v[156:159], a[16:31]
    v_mfma_f32_32x32x16_bf16 a[32:47], a[128:131], v[160:163], a[32:47]
    buffer_load_dwordx4 v[128:131], v9, s[12:15], s42 offen offset:2048 sc1
    v_mfma_f32_32x32x16_bf16 a[48:63], a[128:131], v[164:167], a[48:63]
    s_waitcnt vmcnt(13)
    v_mfma_f32_32x32x16_bf16 a[0:15], a[112:115], v[168:171], a[0:15]
    buffer_load_dwordx4 v[132:135], v10, s[12:15], s42 offen offset:2048 sc1
    v_mfma_f32_32x32x16_bf16 a[16:31], a[112:115], v[172:175], a[16:31]
    v_mfma_f32_32x32x16_bf16 a[32:47], a[112:115], v[176:179], a[32:47]
    buffer_load_dwordx4 v[136:139], v11, s[12:15], s42 offen offset:2048 sc1
    v_mfma_f32_32x32x16_bf16 a[48:63], a[112:115], v[180:183], a[48:63]
    buffer_load_dwordx4 v[140:143], v12, s[12:15], s42 offen offset:2048 sc1
    s_waitcnt vmcnt(15)
    v_mfma_f32_32x32x16_bf16 a[0:15], a[124:127], v[172:175], a[0:15]
    v_mfma_f32_32x32x16_bf16 a[16:31], a[124:127], v[176:179], a[16:31]
    s_mov_b32 s38, 20480
    buffer_load_dwordx4 a[144:147], v3, s[16:19], s38 offen offset:0 sc1
    v_mfma_f32_32x32x16_bf16 a[32:47], a[124:127], v[180:183], a[32:47]
    v_mfma_f32_32x32x16_bf16 a[48:63], a[124:127], v[184:187], a[48:63]
    s_mov_b32 s38, 20480
    buffer_load_dwordx4 a[156:159], v3, s[16:19], s38 offen offset:3072 sc1
    s_waitcnt vmcnt(16)
    v_mfma_f32_32x32x16_bf16 a[0:15], a[136:139], v[176:179], a[0:15]
    v_mfma_f32_32x32x16_bf16 a[16:31], a[136:139], v[180:183], a[16:31]
    s_mov_b32 s38, 24576
    buffer_load_dwordx4 a[168:171], v3, s[16:19], s38 offen offset:2048 sc1
    v_mfma_f32_32x32x16_bf16 a[32:47], a[136:139], v[184:187], a[32:47]
    v_mfma_f32_32x32x16_bf16 a[48:63], a[136:139], v[188:191], a[48:63]
    s_mov_b32 s38, 20480
    buffer_load_dwordx4 a[152:155], v3, s[16:19], s38 offen offset:2048 sc1
    s_waitcnt vmcnt(16)
    v_mfma_f32_32x32x16_bf16 a[0:15], a[148:151], v[72:75], a[0:15]
    s_mov_b32 s38, 24576
    buffer_load_dwordx4 a[164:167], v3, s[16:19], s38 offen offset:1024 sc1
    s_waitcnt vmcnt(16)
    v_mfma_f32_32x32x16_bf16 a[16:31], a[148:151], v[76:79], a[16:31]
    s_waitcnt vmcnt(15)
    v_mfma_f32_32x32x16_bf16 a[32:47], a[148:151], v[80:83], a[32:47]
    v_and_b32_dpp v144, v72, v4 wave_shr:1 row_mask:0xf bank_mask:0xf bound_ctrl:0
    v_and_b32_dpp v145, v73, v4 wave_shr:1 row_mask:0xf bank_mask:0xf bound_ctrl:0
    s_mov_b32 s38, 28672
    buffer_load_dwordx4 a[176:179], v3, s[16:19], s38 offen offset:0 sc1
    s_waitcnt vmcnt(15)
    v_mfma_f32_32x32x16_bf16 a[48:63], a[148:151], v[84:87], a[48:63]
    v_and_b32_dpp v146, v74, v4 wave_shr:1 row_mask:0xf bank_mask:0xf bound_ctrl:0
    v_and_b32_dpp v147, v75, v4 wave_shr:1 row_mask:0xf bank_mask:0xf bound_ctrl:0
    s_waitcnt vmcnt(14)
    v_mfma_f32_32x32x16_bf16 a[0:15], a[160:163], v[76:79], a[0:15]
    v_and_b32_dpp v148, v76, v4 wave_shr:1 row_mask:0xf bank_mask:0xf bound_ctrl:0
    v_and_b32_dpp v149, v77, v4 wave_shr:1 row_mask:0xf bank_mask:0xf bound_ctrl:0
    s_mov_b32 s38, 28672
    buffer_load_dwordx4 a[68:71], v3, s[16:19], s38 offen offset:3072 sc1
    v_mfma_f32_32x32x16_bf16 a[16:31], a[160:163], v[80:83], a[16:31]
    v_and_b32_dpp v150, v78, v4 wave_shr:1 row_mask:0xf bank_mask:0xf bound_ctrl:0
    v_and_b32_dpp v151, v79, v4 wave_shr:1 row_mask:0xf bank_mask:0xf bound_ctrl:0
    v_mfma_f32_32x32x16_bf16 a[32:47], a[160:163], v[84:87], a[32:47]
    v_and_b32_dpp v152, v80, v4 wave_shr:1 row_mask:0xf bank_mask:0xf bound_ctrl:0
    v_and_b32_dpp v153, v81, v4 wave_shr:1 row_mask:0xf bank_mask:0xf bound_ctrl:0
    buffer_load_dwordx4 v[24:27], v8, s[12:15], 0 offen offset:3072 sc1
    s_waitcnt vmcnt(15)
    v_mfma_f32_32x32x16_bf16 a[48:63], a[160:163], v[88:91], a[48:63]
    v_and_b32_dpp v154, v82, v4 wave_shr:1 row_mask:0xf bank_mask:0xf bound_ctrl:0
    v_and_b32_dpp v155, v83, v4 wave_shr:1 row_mask:0xf bank_mask:0xf bound_ctrl:0
    s_waitcnt vmcnt(14)
    v_mfma_f32_32x32x16_bf16 a[0:15], a[172:175], v[80:83], a[0:15]
    v_and_b32_dpp v156, v84, v4 wave_shr:1 row_mask:0xf bank_mask:0xf bound_ctrl:0
    v_and_b32_dpp v157, v85, v4 wave_shr:1 row_mask:0xf bank_mask:0xf bound_ctrl:0
    buffer_load_dwordx4 v[28:31], v9, s[12:15], 0 offen offset:3072 sc1
    v_mfma_f32_32x32x16_bf16 a[16:31], a[172:175], v[84:87], a[16:31]
    v_and_b32_dpp v158, v86, v4 wave_shr:1 row_mask:0xf bank_mask:0xf bound_ctrl:0
    v_and_b32_dpp v159, v87, v4 wave_shr:1 row_mask:0xf bank_mask:0xf bound_ctrl:0
    v_mfma_f32_32x32x16_bf16 a[32:47], a[172:175], v[88:91], a[32:47]
    v_and_b32_dpp v160, v88, v4 wave_shr:1 row_mask:0xf bank_mask:0xf bound_ctrl:0
    v_and_b32_dpp v161, v89, v4 wave_shr:1 row_mask:0xf bank_mask:0xf bound_ctrl:0
    buffer_load_dwordx4 v[32:35], v10, s[12:15], 0 offen offset:3072 sc1
    s_waitcnt vmcnt(15)
    v_mfma_f32_32x32x16_bf16 a[48:63], a[172:175], v[92:95], a[48:63]
    v_and_b32_dpp v162, v90, v4 wave_shr:1 row_mask:0xf bank_mask:0xf bound_ctrl:0
    v_and_b32_dpp v163, v91, v4 wave_shr:1 row_mask:0xf bank_mask:0xf bound_ctrl:0
    buffer_load_dwordx4 v[36:39], v11, s[12:15], 0 offen offset:3072 sc1
    s_waitcnt vmcnt(14)
    v_mfma_f32_32x32x16_bf16 a[0:15], a[180:183], v[128:131], a[0:15]
    v_and_b32_dpp v164, v92, v4 wave_shr:1 row_mask:0xf bank_mask:0xf bound_ctrl:0
    v_and_b32_dpp v165, v93, v4 wave_shr:1 row_mask:0xf bank_mask:0xf bound_ctrl:0
    s_waitcnt vmcnt(13)
    v_mfma_f32_32x32x16_bf16 a[16:31], a[180:183], v[132:135], a[16:31]
    v_and_b32_dpp v166, v94, v4 wave_shr:1 row_mask:0xf bank_mask:0xf bound_ctrl:0
    v_and_b32_dpp v167, v95, v4 wave_shr:1 row_mask:0xf bank_mask:0xf bound_ctrl:0
    s_mov_b32 s38, 32768
    buffer_load_dwordx4 a[80:83], v3, s[16:19], s38 offen offset:2048 sc1
    s_waitcnt vmcnt(13)
    v_mfma_f32_32x32x16_bf16 a[32:47], a[180:183], v[136:139], a[32:47]
    s_waitcnt vmcnt(12)
    v_mfma_f32_32x32x16_bf16 a[48:63], a[180:183], v[140:143], a[48:63]
    buffer_load_dwordx4 v[40:43], v12, s[12:15], 0 offen offset:3072 sc1
    s_waitcnt vmcnt(12)
    v_mfma_f32_32x32x16_bf16 a[0:15], a[144:147], v[144:147], a[0:15]
    v_and_b32_dpp v168, v72, v5 wave_shl:1 row_mask:0xf bank_mask:0xf bound_ctrl:0
    v_and_b32_dpp v169, v73, v5 wave_shl:1 row_mask:0xf bank_mask:0xf bound_ctrl:0
    v_and_b32_dpp v170, v74, v5 wave_shl:1 row_mask:0xf bank_mask:0xf bound_ctrl:0
    v_mfma_f32_32x32x16_bf16 a[16:31], a[144:147], v[148:151], a[16:31]
    v_and_b32_dpp v171, v75, v5 wave_shl:1 row_mask:0xf bank_mask:0xf bound_ctrl:0
    v_and_b32_dpp v172, v76, v5 wave_shl:1 row_mask:0xf bank_mask:0xf bound_ctrl:0
    v_and_b32_dpp v173, v77, v5 wave_shl:1 row_mask:0xf bank_mask:0xf bound_ctrl:0
    s_mov_b32 s38, 36864
    buffer_load_dwordx4 a[92:95], v3, s[16:19], s38 offen offset:1024 sc1
    v_mfma_f32_32x32x16_bf16 a[32:47], a[144:147], v[152:155], a[32:47]
    v_and_b32_dpp v174, v78, v5 wave_shl:1 row_mask:0xf bank_mask:0xf bound_ctrl:0
    v_and_b32_dpp v175, v79, v5 wave_shl:1 row_mask:0xf bank_mask:0xf bound_ctrl:0
    v_and_b32_dpp v176, v80, v5 wave_shl:1 row_mask:0xf bank_mask:0xf bound_ctrl:0
    v_mfma_f32_32x32x16_bf16 a[48:63], a[144:147], v[156:159], a[48:63]
    v_and_b32_dpp v177, v81, v5 wave_shl:1 row_mask:0xf bank_mask:0xf bound_ctrl:0
    v_and_b32_dpp v178, v82, v5 wave_shl:1 row_mask:0xf bank_mask:0xf bound_ctrl:0
    v_and_b32_dpp v179, v83, v5 wave_shl:1 row_mask:0xf bank_mask:0xf bound_ctrl:0
    buffer_load_dwordx4 v[44:47], v13, s[12:15], 0 offen offset:3072 sc1
    s_waitcnt vmcnt(13)
    v_mfma_f32_32x32x16_bf16 a[0:15], a[156:159], v[148:151], a[0:15]
    v_and_b32_dpp v180, v84, v5 wave_shl:1 row_mask:0xf bank_mask:0xf bound_ctrl:0
    v_and_b32_dpp v181, v85, v5 wave_shl:1 row_mask:0xf bank_mask:0xf bound_ctrl:0
    v_and_b32_dpp v182, v86, v5 wave_shl:1 row_mask:0xf bank_mask:0xf bound_ctrl:0
    s_mov_b32 s38, 36864
    buffer_load_dwordx4 a[100:103], v3, s[16:19], s38 offen offset:3072 sc1
    v_mfma_f32_32x32x16_bf16 a[16:31], a[156:159], v[152:155], a[16:31]
    v_and_b32_dpp v183, v87, v5 wave_shl:1 row_mask:0xf bank_mask:0xf bound_ctrl:0
    v_and_b32_dpp v184, v88, v5 wave_shl:1 row_mask:0xf bank_mask:0xf bound_ctrl:0
    v_and_b32_dpp v185, v89, v5 wave_shl:1 row_mask:0xf bank_mask:0xf bound_ctrl:0
    v_mfma_f32_32x32x16_bf16 a[32:47], a[156:159], v[156:159], a[32:47]
    v_and_b32_dpp v186, v90, v5 wave_shl:1 row_mask:0xf bank_mask:0xf bound_ctrl:0
    v_and_b32_dpp v187, v91, v5 wave_shl:1 row_mask:0xf bank_mask:0xf bound_ctrl:0
    v_and_b32_dpp v188, v92, v5 wave_shl:1 row_mask:0xf bank_mask:0xf bound_ctrl:0
    buffer_load_dwordx4 v[96:99], v9, s[12:15], s42 offen offset:3072 sc1
    v_mfma_f32_32x32x16_bf16 a[48:63], a[156:159], v[160:163], a[48:63]
    v_and_b32_dpp v189, v93, v5 wave_shl:1 row_mask:0xf bank_mask:0xf bound_ctrl:0
    v_and_b32_dpp v190, v94, v5 wave_shl:1 row_mask:0xf bank_mask:0xf bound_ctrl:0
    v_and_b32_dpp v191, v95, v5 wave_shl:1 row_mask:0xf bank_mask:0xf bound_ctrl:0
    s_waitcnt vmcnt(14)
    v_mfma_f32_32x32x16_bf16 a[0:15], a[168:171], v[152:155], a[0:15]
    buffer_load_dwordx4 v[100:103], v10, s[12:15], s42 offen offset:3072 sc1
    v_mfma_f32_32x32x16_bf16 a[16:31], a[168:171], v[156:159], a[16:31]
    v_mfma_f32_32x32x16_bf16 a[32:47], a[168:171], v[160:163], a[32:47]
    buffer_load_dwordx4 v[104:107], v11, s[12:15], s42 offen offset:3072 sc1
    v_mfma_f32_32x32x16_bf16 a[48:63], a[168:171], v[164:167], a[48:63]
    s_waitcnt vmcnt(15)
    v_mfma_f32_32x32x16_bf16 a[0:15], a[152:155], v[168:171], a[0:15]
    buffer_load_dwordx4 v[108:111], v12, s[12:15], s42 offen offset:3072 sc1
    v_mfma_f32_32x32x16_bf16 a[16:31], a[152:155], v[172:175], a[16:31]
    v_mfma_f32_32x32x16_bf16 a[32:47], a[152:155], v[176:179], a[32:47]
    s_mov_b32 s38, 28672
    buffer_load_dwordx4 a[64:67], v3, s[16:19], s38 offen offset:2048 sc1
    v_mfma_f32_32x32x16_bf16 a[48:63], a[152:155], v[180:183], a[48:63]
    s_mov_b32 s38, 32768
    buffer_load_dwordx4 a[76:79], v3, s[16:19], s38 offen offset:1024 sc1
    s_waitcnt vmcnt(17)
    v_mfma_f32_32x32x16_bf16 a[0:15], a[164:167], v[172:175], a[0:15]
    v_mfma_f32_32x32x16_bf16 a[16:31], a[164:167], v[176:179], a[16:31]
    s_mov_b32 s38, 36864
    buffer_load_dwordx4 a[88:91], v3, s[16:19], s38 offen offset:0 sc1
    v_mfma_f32_32x32x16_bf16 a[32:47], a[164:167], v[180:183], a[32:47]
    v_mfma_f32_32x32x16_bf16 a[48:63], a[164:167], v[184:187], a[48:63]
    s_mov_b32 s38, 32768
    buffer_load_dwordx4 a[72:75], v3, s[16:19], s38 offen offset:0 sc1
    s_waitcnt vmcnt(18)
    v_mfma_f32_32x32x16_bf16 a[0:15], a[176:179], v[176:179], a[0:15]
    v_mfma_f32_32x32x16_bf16 a[16:31], a[176:179], v[180:183], a[16:31]
    s_mov_b32 s38, 32768
    buffer_load_dwordx4 a[84:87], v3, s[16:19], s38 offen offset:3072 sc1
    v_mfma_f32_32x32x16_bf16 a[32:47], a[176:179], v[184:187], a[32:47]
    v_mfma_f32_32x32x16_bf16 a[48:63], a[176:179], v[188:191], a[48:63]
    s_mov_b32 s38, 36864
    buffer_load_dwordx4 a[96:99], v3, s[16:19], s38 offen offset:2048 sc1
    s_waitcnt vmcnt(18)
    v_mfma_f32_32x32x16_bf16 a[0:15], a[68:71], v[24:27], a[0:15]
    s_mov_b32 s38, 40960
    buffer_load_dwordx4 a[108:111], v3, s[16:19], s38 offen offset:1024 sc1
    s_waitcnt vmcnt(18)
    v_mfma_f32_32x32x16_bf16 a[16:31], a[68:71], v[28:31], a[16:31]
    s_waitcnt vmcnt(17)
    v_mfma_f32_32x32x16_bf16 a[32:47], a[68:71], v[32:35], a[32:47]
    v_and_b32_dpp v144, v24, v4 wave_shr:1 row_mask:0xf bank_mask:0xf bound_ctrl:0
    v_and_b32_dpp v145, v25, v4 wave_shr:1 row_mask:0xf bank_mask:0xf bound_ctrl:0
    buffer_load_dwordx4 v[48:51], v8, s[12:15], s33 offen offset:0 sc1
    s_waitcnt vmcnt(17)
    v_mfma_f32_32x32x16_bf16 a[48:63], a[68:71], v[36:39], a[48:63]
    v_and_b32_dpp v146, v26, v4 wave_shr:1 row_mask:0xf bank_mask:0xf bound_ctrl:0
    v_and_b32_dpp v147, v27, v4 wave_shr:1 row_mask:0xf bank_mask:0xf bound_ctrl:0
    s_waitcnt vmcnt(16)
    v_mfma_f32_32x32x16_bf16 a[0:15], a[80:83], v[28:31], a[0:15]
    v_and_b32_dpp v148, v28, v4 wave_shr:1 row_mask:0xf bank_mask:0xf bound_ctrl:0
    v_and_b32_dpp v149, v29, v4 wave_shr:1 row_mask:0xf bank_mask:0xf bound_ctrl:0
    buffer_load_dwordx4 v[52:55], v9, s[12:15], s33 offen offset:0 sc1
    v_mfma_f32_32x32x16_bf16 a[16:31], a[80:83], v[32:35], a[16:31]
    v_and_b32_dpp v150, v30, v4 wave_shr:1 row_mask:0xf bank_mask:0xf bound_ctrl:0
    v_and_b32_dpp v151, v31, v4 wave_shr:1 row_mask:0xf bank_mask:0xf bound_ctrl:0
    v_mfma_f32_32x32x16_bf16 a[32:47], a[80:83], v[36:39], a[32:47]
    v_and_b32_dpp v152, v32, v4 wave_shr:1 row_mask:0xf bank_mask:0xf bound_ctrl:0
    v_and_b32_dpp v153, v33, v4 wave_shr:1 row_mask:0xf bank_mask:0xf bound_ctrl:0
    buffer_load_dwordx4 v[56:59], v10, s[12:15], s33 offen offset:0 sc1
    s_waitcnt vmcnt(17)
    v_mfma_f32_32x32x16_bf16 a[48:63], a[80:83], v[40:43], a[48:63]
    v_and_b32_dpp v154, v34, v4 wave_shr:1 row_mask:0xf bank_mask:0xf bound_ctrl:0
    v_and_b32_dpp v155, v35, v4 wave_shr:1 row_mask:0xf bank_mask:0xf bound_ctrl:0
    s_waitcnt vmcnt(16)
    v_mfma_f32_32x32x16_bf16 a[0:15], a[92:95], v[32:35], a[0:15]
    v_and_b32_dpp v156, v36, v4 wave_shr:1 row_mask:0xf bank_mask:0xf bound_ctrl:0
    v_and_b32_dpp v157, v37, v4 wave_shr:1 row_mask:0xf bank_mask:0xf bound_ctrl:0
    buffer_load_dwordx4 v[60:63], v11, s[12:15], s33 offen offset:0 sc1
    v_mfma_f32_32x32x16_bf16 a[16:31], a[92:95], v[36:39], a[16:31]
    v_and_b32_dpp v158, v38, v4 wave_shr:1 row_mask:0xf bank_mask:0xf bound_ctrl:0
    v_and_b32_dpp v159, v39, v4 wave_shr:1 row_mask:0xf bank_mask:0xf bound_ctrl:0
    v_mfma_f32_32x32x16_bf16 a[32:47], a[92:95], v[40:43], a[32:47]
    v_and_b32_dpp v160, v40, v4 wave_shr:1 row_mask:0xf bank_mask:0xf bound_ctrl:0
    v_and_b32_dpp v161, v41, v4 wave_shr:1 row_mask:0xf bank_mask:0xf bound_ctrl:0
    s_mov_b32 s38, 45056
    buffer_load_dwordx4 a[120:123], v3, s[16:19], s38 offen offset:0 sc1
    s_waitcnt vmcnt(17)
    v_mfma_f32_32x32x16_bf16 a[48:63], a[92:95], v[44:47], a[48:63]
    v_and_b32_dpp v162, v42, v4 wave_shr:1 row_mask:0xf bank_mask:0xf bound_ctrl:0
    v_and_b32_dpp v163, v43, v4 wave_shr:1 row_mask:0xf bank_mask:0xf bound_ctrl:0
    buffer_load_dwordx4 v[64:67], v12, s[12:15], s33 offen offset:0 sc1
    s_waitcnt vmcnt(16)
    v_mfma_f32_32x32x16_bf16 a[0:15], a[100:103], v[96:99], a[0:15]
    v_and_b32_dpp v164, v44, v4 wave_shr:1 row_mask:0xf bank_mask:0xf bound_ctrl:0
    v_and_b32_dpp v165, v45, v4 wave_shr:1 row_mask:0xf bank_mask:0xf bound_ctrl:0
    s_waitcnt vmcnt(15)
    v_mfma_f32_32x32x16_bf16 a[16:31], a[100:103], v[100:103], a[16:31]
    v_and_b32_dpp v166, v46, v4 wave_shr:1 row_mask:0xf bank_mask:0xf bound_ctrl:0
    v_and_b32_dpp v167, v47, v4 wave_shr:1 row_mask:0xf bank_mask:0xf bound_ctrl:0
    s_mov_b32 s38, 45056
    buffer_load_dwordx4 a[132:135], v3, s[16:19], s38 offen offset:3072 sc1
    s_waitcnt vmcnt(15)
    v_mfma_f32_32x32x16_bf16 a[32:47], a[100:103], v[104:107], a[32:47]
    s_waitcnt vmcnt(14)
    v_mfma_f32_32x32x16_bf16 a[48:63], a[100:103], v[108:111], a[48:63]
    buffer_load_dwordx4 v[68:71], v13, s[12:15], s33 offen offset:0 sc1
    s_waitcnt vmcnt(14)
    v_mfma_f32_32x32x16_bf16 a[0:15], a[64:67], v[144:147], a[0:15]
    v_and_b32_dpp v168, v24, v5 wave_shl:1 row_mask:0xf bank_mask:0xf bound_ctrl:0
    v_and_b32_dpp v169, v25, v5 wave_shl:1 row_mask:0xf bank_mask:0xf bound_ctrl:0
    v_and_b32_dpp v170, v26, v5 wave_shl:1 row_mask:0xf bank_mask:0xf bound_ctrl:0
    v_mfma_f32_32x32x16_bf16 a[16:31], a[64:67], v[148:151], a[16:31]
    v_and_b32_dpp v171, v27, v5 wave_shl:1 row_mask:0xf bank_mask:0xf bound_ctrl:0
    v_and_b32_dpp v172, v28, v5 wave_shl:1 row_mask:0xf bank_mask:0xf bound_ctrl:0
    v_and_b32_dpp v173, v29, v5 wave_shl:1 row_mask:0xf bank_mask:0xf bound_ctrl:0
    s_mov_b32 s38, 49152
    buffer_load_dwordx4 a[140:143], v3, s[16:19], s38 offen offset:1024 sc1
    v_mfma_f32_32x32x16_bf16 a[32:47], a[64:67], v[152:155], a[32:47]
    v_and_b32_dpp v174, v30, v5 wave_shl:1 row_mask:0xf bank_mask:0xf bound_ctrl:0
    v_and_b32_dpp v175, v31, v5 wave_shl:1 row_mask:0xf bank_mask:0xf bound_ctrl:0
    v_and_b32_dpp v176, v32, v5 wave_shl:1 row_mask:0xf bank_mask:0xf bound_ctrl:0
    v_mfma_f32_32x32x16_bf16 a[48:63], a[64:67], v[156:159], a[48:63]
    v_and_b32_dpp v177, v33, v5 wave_shl:1 row_mask:0xf bank_mask:0xf bound_ctrl:0
    v_and_b32_dpp v178, v34, v5 wave_shl:1 row_mask:0xf bank_mask:0xf bound_ctrl:0
    v_and_b32_dpp v179, v35, v5 wave_shl:1 row_mask:0xf bank_mask:0xf bound_ctrl:0
    buffer_load_dwordx4 v[112:115], v9, s[12:15], s43 offen offset:0 sc1
    s_waitcnt vmcnt(15)
    v_mfma_f32_32x32x16_bf16 a[0:15], a[76:79], v[148:151], a[0:15]
    v_and_b32_dpp v180, v36, v5 wave_shl:1 row_mask:0xf bank_mask:0xf bound_ctrl:0
    v_and_b32_dpp v181, v37, v5 wave_shl:1 row_mask:0xf bank_mask:0xf bound_ctrl:0
    v_and_b32_dpp v182, v38, v5 wave_shl:1 row_mask:0xf bank_mask:0xf bound_ctrl:0
    buffer_load_dwordx4 v[116:119], v10, s[12:15], s43 offen offset:0 sc1
    v_mfma_f32_32x32x16_bf16 a[16:31], a[76:79], v[152:155], a[16:31]
    v_and_b32_dpp v183, v39, v5 wave_shl:1 row_mask:0xf bank_mask:0xf bound_ctrl:0
    v_and_b32_dpp v184, v40, v5 wave_shl:1 row_mask:0xf bank_mask:0xf bound_ctrl:0
    v_and_b32_dpp v185, v41, v5 wave_shl:1 row_mask:0xf bank_mask:0xf bound_ctrl:0
    v_mfma_f32_32x32x16_bf16 a[32:47], a[76:79], v[156:159], a[32:47]
    v_and_b32_dpp v186, v42, v5 wave_shl:1 row_mask:0xf bank_mask:0xf bound_ctrl:0
    v_and_b32_dpp v187, v43, v5 wave_shl:1 row_mask:0xf bank_mask:0xf bound_ctrl:0
    v_and_b32_dpp v188, v44, v5 wave_shl:1 row_mask:0xf bank_mask:0xf bound_ctrl:0
    buffer_load_dwordx4 v[120:123], v11, s[12:15], s43 offen offset:0 sc1
    v_mfma_f32_32x32x16_bf16 a[48:63], a[76:79], v[160:163], a[48:63]
    v_and_b32_dpp v189, v45, v5 wave_shl:1 row_mask:0xf bank_mask:0xf bound_ctrl:0
    v_and_b32_dpp v190, v46, v5 wave_shl:1 row_mask:0xf bank_mask:0xf bound_ctrl:0
    v_and_b32_dpp v191, v47, v5 wave_shl:1 row_mask:0xf bank_mask:0xf bound_ctrl:0
    s_waitcnt vmcnt(16)
    v_mfma_f32_32x32x16_bf16 a[0:15], a[88:91], v[152:155], a[0:15]
    buffer_load_dwordx4 v[124:127], v12, s[12:15], s43 offen offset:0 sc1
    v_mfma_f32_32x32x16_bf16 a[16:31], a[88:91], v[156:159], a[16:31]
    v_mfma_f32_32x32x16_bf16 a[32:47], a[88:91], v[160:163], a[32:47]
    s_mov_b32 s38, 40960
    buffer_load_dwordx4 a[104:107], v3, s[16:19], s38 offen offset:0 sc1
    v_mfma_f32_32x32x16_bf16 a[48:63], a[88:91], v[164:167], a[48:63]
    s_waitcnt vmcnt(17)
    v_mfma_f32_32x32x16_bf16 a[0:15], a[72:75], v[168:171], a[0:15]
    s_mov_b32 s38, 40960
    buffer_load_dwordx4 a[116:119], v3, s[16:19], s38 offen offset:3072 sc1
    v_mfma_f32_32x32x16_bf16 a[16:31], a[72:75], v[172:175], a[16:31]
    v_mfma_f32_32x32x16_bf16 a[32:47], a[72:75], v[176:179], a[32:47]
    s_mov_b32 s38, 45056
    buffer_load_dwordx4 a[128:131], v3, s[16:19], s38 offen offset:2048 sc1
    v_mfma_f32_32x32x16_bf16 a[48:63], a[72:75], v[180:183], a[48:63]
    s_mov_b32 s38, 40960
    buffer_load_dwordx4 a[112:115], v3, s[16:19], s38 offen offset:2048 sc1
    s_waitcnt vmcnt(19)
    v_mfma_f32_32x32x16_bf16 a[0:15], a[84:87], v[172:175], a[0:15]
    v_mfma_f32_32x32x16_bf16 a[16:31], a[84:87], v[176:179], a[16:31]
    s_mov_b32 s38, 45056
    buffer_load_dwordx4 a[124:127], v3, s[16:19], s38 offen offset:1024 sc1
    v_mfma_f32_32x32x16_bf16 a[32:47], a[84:87], v[180:183], a[32:47]
    v_mfma_f32_32x32x16_bf16 a[48:63], a[84:87], v[184:187], a[48:63]
    s_mov_b32 s38, 49152
    buffer_load_dwordx4 a[136:139], v3, s[16:19], s38 offen offset:0 sc1
    s_waitcnt vmcnt(20)
    v_mfma_f32_32x32x16_bf16 a[0:15], a[96:99], v[176:179], a[0:15]
    v_mfma_f32_32x32x16_bf16 a[16:31], a[96:99], v[180:183], a[16:31]
    s_mov_b32 s38, 49152
    buffer_load_dwordx4 a[148:151], v3, s[16:19], s38 offen offset:3072 sc1
    v_mfma_f32_32x32x16_bf16 a[32:47], a[96:99], v[184:187], a[32:47]
    v_mfma_f32_32x32x16_bf16 a[48:63], a[96:99], v[188:191], a[48:63]
    buffer_load_dwordx4 v[72:75], v8, s[12:15], s33 offen offset:1024 sc1
    s_waitcnt vmcnt(20)
    v_mfma_f32_32x32x16_bf16 a[0:15], a[108:111], v[48:51], a[0:15]
    buffer_load_dwordx4 v[76:79], v9, s[12:15], s33 offen offset:1024 sc1
    s_waitcnt vmcnt(20)
    v_mfma_f32_32x32x16_bf16 a[16:31], a[108:111], v[52:55], a[16:31]
    s_waitcnt vmcnt(19)
    v_mfma_f32_32x32x16_bf16 a[32:47], a[108:111], v[56:59], a[32:47]
    v_and_b32_dpp v144, v48, v4 wave_shr:1 row_mask:0xf bank_mask:0xf bound_ctrl:0
    v_and_b32_dpp v145, v49, v4 wave_shr:1 row_mask:0xf bank_mask:0xf bound_ctrl:0
    buffer_load_dwordx4 v[80:83], v10, s[12:15], s33 offen offset:1024 sc1
    s_waitcnt vmcnt(19)
    v_mfma_f32_32x32x16_bf16 a[48:63], a[108:111], v[60:63], a[48:63]
    v_and_b32_dpp v146, v50, v4 wave_shr:1 row_mask:0xf bank_mask:0xf bound_ctrl:0
    v_and_b32_dpp v147, v51, v4 wave_shr:1 row_mask:0xf bank_mask:0xf bound_ctrl:0
    s_waitcnt vmcnt(18)
    v_mfma_f32_32x32x16_bf16 a[0:15], a[120:123], v[52:55], a[0:15]
    v_and_b32_dpp v148, v52, v4 wave_shr:1 row_mask:0xf bank_mask:0xf bound_ctrl:0
    v_and_b32_dpp v149, v53, v4 wave_shr:1 row_mask:0xf bank_mask:0xf bound_ctrl:0
    buffer_load_dwordx4 v[84:87], v11, s[12:15], s33 offen offset:1024 sc1
    v_mfma_f32_32x32x16_bf16 a[16:31], a[120:123], v[56:59], a[16:31]
    v_and_b32_dpp v150, v54, v4 wave_shr:1 row_mask:0xf bank_mask:0xf bound_ctrl:0
    v_and_b32_dpp v151, v55, v4 wave_shr:1 row_mask:0xf bank_mask:0xf bound_ctrl:0
    v_mfma_f32_32x32x16_bf16 a[32:47], a[120:123], v[60:63], a[32:47]
    v_and_b32_dpp v152, v56, v4 wave_shr:1 row_mask:0xf bank_mask:0xf bound_ctrl:0
    v_and_b32_dpp v153, v57, v4 wave_shr:1 row_mask:0xf bank_mask:0xf bound_ctrl:0
    s_mov_b32 s38, 53248
    buffer_load_dwordx4 a[160:163], v3, s[16:19], s38 offen offset:2048 sc1
    s_waitcnt vmcnt(19)
    v_mfma_f32_32x32x16_bf16 a[48:63], a[120:123], v[64:67], a[48:63]
    v_and_b32_dpp v154, v58, v4 wave_shr:1 row_mask:0xf bank_mask:0xf bound_ctrl:0
    v_and_b32_dpp v155, v59, v4 wave_shr:1 row_mask:0xf bank_mask:0xf bound_ctrl:0
    s_waitcnt vmcnt(18)
    v_mfma_f32_32x32x16_bf16 a[0:15], a[132:135], v[56:59], a[0:15]
    v_and_b32_dpp v156, v60, v4 wave_shr:1 row_mask:0xf bank_mask:0xf bound_ctrl:0
    v_and_b32_dpp v157, v61, v4 wave_shr:1 row_mask:0xf bank_mask:0xf bound_ctrl:0
    buffer_load_dwordx4 v[88:91], v12, s[12:15], s33 offen offset:1024 sc1
    v_mfma_f32_32x32x16_bf16 a[16:31], a[132:135], v[60:63], a[16:31]
    v_and_b32_dpp v158, v62, v4 wave_shr:1 row_mask:0xf bank_mask:0xf bound_ctrl:0
    v_and_b32_dpp v159, v63, v4 wave_shr:1 row_mask:0xf bank_mask:0xf bound_ctrl:0
    v_mfma_f32_32x32x16_bf16 a[32:47], a[132:135], v[64:67], a[32:47]
    v_and_b32_dpp v160, v64, v4 wave_shr:1 row_mask:0xf bank_mask:0xf bound_ctrl:0
    v_and_b32_dpp v161, v65, v4 wave_shr:1 row_mask:0xf bank_mask:0xf bound_ctrl:0
    s_mov_b32 s38, 57344
    buffer_load_dwordx4 a[172:175], v3, s[16:19], s38 offen offset:1024 sc1
    s_waitcnt vmcnt(19)
    v_mfma_f32_32x32x16_bf16 a[48:63], a[132:135], v[68:71], a[48:63]
    v_and_b32_dpp v162, v66, v4 wave_shr:1 row_mask:0xf bank_mask:0xf bound_ctrl:0
    v_and_b32_dpp v163, v67, v4 wave_shr:1 row_mask:0xf bank_mask:0xf bound_ctrl:0
    buffer_load_dwordx4 v[92:95], v13, s[12:15], s33 offen offset:1024 sc1
    s_waitcnt vmcnt(18)
    v_mfma_f32_32x32x16_bf16 a[0:15], a[140:143], v[112:115], a[0:15]
    v_and_b32_dpp v164, v68, v4 wave_shr:1 row_mask:0xf bank_mask:0xf bound_ctrl:0
    v_and_b32_dpp v165, v69, v4 wave_shr:1 row_mask:0xf bank_mask:0xf bound_ctrl:0
    s_waitcnt vmcnt(17)
    v_mfma_f32_32x32x16_bf16 a[16:31], a[140:143], v[116:119], a[16:31]
    v_and_b32_dpp v166, v70, v4 wave_shr:1 row_mask:0xf bank_mask:0xf bound_ctrl:0
    v_and_b32_dpp v167, v71, v4 wave_shr:1 row_mask:0xf bank_mask:0xf bound_ctrl:0
    s_mov_b32 s38, 57344
    buffer_load_dwordx4 a[180:183], v3, s[16:19], s38 offen offset:3072 sc1
    s_waitcnt vmcnt(17)
    v_mfma_f32_32x32x16_bf16 a[32:47], a[140:143], v[120:123], a[32:47]
    s_waitcnt vmcnt(16)
    v_mfma_f32_32x32x16_bf16 a[48:63], a[140:143], v[124:127], a[48:63]
    buffer_load_dwordx4 v[128:131], v9, s[12:15], s43 offen offset:1024 sc1
    s_waitcnt vmcnt(16)
    v_mfma_f32_32x32x16_bf16 a[0:15], a[104:107], v[144:147], a[0:15]
    v_and_b32_dpp v168, v48, v5 wave_shl:1 row_mask:0xf bank_mask:0xf bound_ctrl:0
    v_and_b32_dpp v169, v49, v5 wave_shl:1 row_mask:0xf bank_mask:0xf bound_ctrl:0
    v_and_b32_dpp v170, v50, v5 wave_shl:1 row_mask:0xf bank_mask:0xf bound_ctrl:0
    v_mfma_f32_32x32x16_bf16 a[16:31], a[104:107], v[148:151], a[16:31]
    v_and_b32_dpp v171, v51, v5 wave_shl:1 row_mask:0xf bank_mask:0xf bound_ctrl:0
    v_and_b32_dpp v172, v52, v5 wave_shl:1 row_mask:0xf bank_mask:0xf bound_ctrl:0
    v_and_b32_dpp v173, v53, v5 wave_shl:1 row_mask:0xf bank_mask:0xf bound_ctrl:0
    buffer_load_dwordx4 v[132:135], v10, s[12:15], s43 offen offset:1024 sc1
    v_mfma_f32_32x32x16_bf16 a[32:47], a[104:107], v[152:155], a[32:47]
    v_and_b32_dpp v174, v54, v5 wave_shl:1 row_mask:0xf bank_mask:0xf bound_ctrl:0
    v_and_b32_dpp v175, v55, v5 wave_shl:1 row_mask:0xf bank_mask:0xf bound_ctrl:0
    v_and_b32_dpp v176, v56, v5 wave_shl:1 row_mask:0xf bank_mask:0xf bound_ctrl:0
    v_mfma_f32_32x32x16_bf16 a[48:63], a[104:107], v[156:159], a[48:63]
    v_and_b32_dpp v177, v57, v5 wave_shl:1 row_mask:0xf bank_mask:0xf bound_ctrl:0
    v_and_b32_dpp v178, v58, v5 wave_shl:1 row_mask:0xf bank_mask:0xf bound_ctrl:0
    v_and_b32_dpp v179, v59, v5 wave_shl:1 row_mask:0xf bank_mask:0xf bound_ctrl:0
    buffer_load_dwordx4 v[136:139], v11, s[12:15], s43 offen offset:1024 sc1
    s_waitcnt vmcnt(17)
    v_mfma_f32_32x32x16_bf16 a[0:15], a[116:119], v[148:151], a[0:15]
    v_and_b32_dpp v180, v60, v5 wave_shl:1 row_mask:0xf bank_mask:0xf bound_ctrl:0
    v_and_b32_dpp v181, v61, v5 wave_shl:1 row_mask:0xf bank_mask:0xf bound_ctrl:0
    v_and_b32_dpp v182, v62, v5 wave_shl:1 row_mask:0xf bank_mask:0xf bound_ctrl:0
    buffer_load_dwordx4 v[140:143], v12, s[12:15], s43 offen offset:1024 sc1
    v_mfma_f32_32x32x16_bf16 a[16:31], a[116:119], v[152:155], a[16:31]
    v_and_b32_dpp v183, v63, v5 wave_shl:1 row_mask:0xf bank_mask:0xf bound_ctrl:0
    v_and_b32_dpp v184, v64, v5 wave_shl:1 row_mask:0xf bank_mask:0xf bound_ctrl:0
    v_and_b32_dpp v185, v65, v5 wave_shl:1 row_mask:0xf bank_mask:0xf bound_ctrl:0
    v_mfma_f32_32x32x16_bf16 a[32:47], a[116:119], v[156:159], a[32:47]
    v_and_b32_dpp v186, v66, v5 wave_shl:1 row_mask:0xf bank_mask:0xf bound_ctrl:0
    v_and_b32_dpp v187, v67, v5 wave_shl:1 row_mask:0xf bank_mask:0xf bound_ctrl:0
    v_and_b32_dpp v188, v68, v5 wave_shl:1 row_mask:0xf bank_mask:0xf bound_ctrl:0
    s_mov_b32 s38, 49152
    buffer_load_dwordx4 a[144:147], v3, s[16:19], s38 offen offset:2048 sc1
    v_mfma_f32_32x32x16_bf16 a[48:63], a[116:119], v[160:163], a[48:63]
    v_and_b32_dpp v189, v69, v5 wave_shl:1 row_mask:0xf bank_mask:0xf bound_ctrl:0
    v_and_b32_dpp v190, v70, v5 wave_shl:1 row_mask:0xf bank_mask:0xf bound_ctrl:0
    v_and_b32_dpp v191, v71, v5 wave_shl:1 row_mask:0xf bank_mask:0xf bound_ctrl:0
    s_waitcnt vmcnt(18)
    v_mfma_f32_32x32x16_bf16 a[0:15], a[128:131], v[152:155], a[0:15]
    s_mov_b32 s38, 53248
    buffer_load_dwordx4 a[156:159], v3, s[16:19], s38 offen offset:1024 sc1
    v_mfma_f32_32x32x16_bf16 a[16:31], a[128:131], v[156:159], a[16:31]
    v_mfma_f32_32x32x16_bf16 a[32:47], a[128:131], v[160:163], a[32:47]
    s_mov_b32 s38, 57344
    buffer_load_dwordx4 a[168:171], v3, s[16:19], s38 offen offset:0 sc1
    v_mfma_f32_32x32x16_bf16 a[48:63], a[128:131], v[164:167], a[48:63]
    s_waitcnt vmcnt(19)
    v_mfma_f32_32x32x16_bf16 a[0:15], a[112:115], v[168:171], a[0:15]
    s_mov_b32 s38, 53248
    buffer_load_dwordx4 a[152:155], v3, s[16:19], s38 offen offset:0 sc1
    v_mfma_f32_32x32x16_bf16 a[16:31], a[112:115], v[172:175], a[16:31]
    v_mfma_f32_32x32x16_bf16 a[32:47], a[112:115], v[176:179], a[32:47]
    s_mov_b32 s38, 53248
    buffer_load_dwordx4 a[164:167], v3, s[16:19], s38 offen offset:3072 sc1
    v_mfma_f32_32x32x16_bf16 a[48:63], a[112:115], v[180:183], a[48:63]
    s_mov_b32 s38, 57344
    buffer_load_dwordx4 a[176:179], v3, s[16:19], s38 offen offset:2048 sc1
    s_waitcnt vmcnt(21)
    v_mfma_f32_32x32x16_bf16 a[0:15], a[124:127], v[172:175], a[0:15]
    v_mfma_f32_32x32x16_bf16 a[16:31], a[124:127], v[176:179], a[16:31]
    s_mov_b32 s38, 61440
    buffer_load_dwordx4 a[68:71], v3, s[16:19], s38 offen offset:1024 sc1
    v_mfma_f32_32x32x16_bf16 a[32:47], a[124:127], v[180:183], a[32:47]
    v_mfma_f32_32x32x16_bf16 a[48:63], a[124:127], v[184:187], a[48:63]
    buffer_load_dwordx4 v[24:27], v8, s[12:15], s33 offen offset:2048 sc1
    s_waitcnt vmcnt(22)
    v_mfma_f32_32x32x16_bf16 a[0:15], a[136:139], v[176:179], a[0:15]
    v_mfma_f32_32x32x16_bf16 a[16:31], a[136:139], v[180:183], a[16:31]
    buffer_load_dwordx4 v[28:31], v9, s[12:15], s33 offen offset:2048 sc1
    v_mfma_f32_32x32x16_bf16 a[32:47], a[136:139], v[184:187], a[32:47]
    v_mfma_f32_32x32x16_bf16 a[48:63], a[136:139], v[188:191], a[48:63]
    buffer_load_dwordx4 v[32:35], v10, s[12:15], s33 offen offset:2048 sc1
    s_waitcnt vmcnt(22)
    v_mfma_f32_32x32x16_bf16 a[0:15], a[148:151], v[72:75], a[0:15]
    buffer_load_dwordx4 v[36:39], v11, s[12:15], s33 offen offset:2048 sc1
    s_waitcnt vmcnt(22)
    v_mfma_f32_32x32x16_bf16 a[16:31], a[148:151], v[76:79], a[16:31]
    s_waitcnt vmcnt(21)
    v_mfma_f32_32x32x16_bf16 a[32:47], a[148:151], v[80:83], a[32:47]
    v_and_b32_dpp v144, v72, v4 wave_shr:1 row_mask:0xf bank_mask:0xf bound_ctrl:0
    v_and_b32_dpp v145, v73, v4 wave_shr:1 row_mask:0xf bank_mask:0xf bound_ctrl:0
    s_mov_b32 s38, 65536
    buffer_load_dwordx4 a[80:83], v3, s[16:19], s38 offen offset:0 sc1
    s_waitcnt vmcnt(21)
    v_mfma_f32_32x32x16_bf16 a[48:63], a[148:151], v[84:87], a[48:63]
    v_and_b32_dpp v146, v74, v4 wave_shr:1 row_mask:0xf bank_mask:0xf bound_ctrl:0
    v_and_b32_dpp v147, v75, v4 wave_shr:1 row_mask:0xf bank_mask:0xf bound_ctrl:0
    s_waitcnt vmcnt(20)
    v_mfma_f32_32x32x16_bf16 a[0:15], a[160:163], v[76:79], a[0:15]
    v_and_b32_dpp v148, v76, v4 wave_shr:1 row_mask:0xf bank_mask:0xf bound_ctrl:0
    v_and_b32_dpp v149, v77, v4 wave_shr:1 row_mask:0xf bank_mask:0xf bound_ctrl:0
    buffer_load_dwordx4 v[40:43], v12, s[12:15], s33 offen offset:2048 sc1
    v_mfma_f32_32x32x16_bf16 a[16:31], a[160:163], v[80:83], a[16:31]
    v_and_b32_dpp v150, v78, v4 wave_shr:1 row_mask:0xf bank_mask:0xf bound_ctrl:0
    v_and_b32_dpp v151, v79, v4 wave_shr:1 row_mask:0xf bank_mask:0xf bound_ctrl:0
    v_mfma_f32_32x32x16_bf16 a[32:47], a[160:163], v[84:87], a[32:47]
    v_and_b32_dpp v152, v80, v4 wave_shr:1 row_mask:0xf bank_mask:0xf bound_ctrl:0
    v_and_b32_dpp v153, v81, v4 wave_shr:1 row_mask:0xf bank_mask:0xf bound_ctrl:0
    s_mov_b32 s38, 65536
    buffer_load_dwordx4 a[92:95], v3, s[16:19], s38 offen offset:3072 sc1
    s_waitcnt vmcnt(21)
    v_mfma_f32_32x32x16_bf16 a[48:63], a[160:163], v[88:91], a[48:63]
    v_and_b32_dpp v154, v82, v4 wave_shr:1 row_mask:0xf bank_mask:0xf bound_ctrl:0
    v_and_b32_dpp v155, v83, v4 wave_shr:1 row_mask:0xf bank_mask:0xf bound_ctrl:0
    s_waitcnt vmcnt(20)
    v_mfma_f32_32x32x16_bf16 a[0:15], a[172:175], v[80:83], a[0:15]
    v_and_b32_dpp v156, v84, v4 wave_shr:1 row_mask:0xf bank_mask:0xf bound_ctrl:0
    v_and_b32_dpp v157, v85, v4 wave_shr:1 row_mask:0xf bank_mask:0xf bound_ctrl:0
    buffer_load_dwordx4 v[44:47], v13, s[12:15], s33 offen offset:2048 sc1
    v_mfma_f32_32x32x16_bf16 a[16:31], a[172:175], v[84:87], a[16:31]
    v_and_b32_dpp v158, v86, v4 wave_shr:1 row_mask:0xf bank_mask:0xf bound_ctrl:0
    v_and_b32_dpp v159, v87, v4 wave_shr:1 row_mask:0xf bank_mask:0xf bound_ctrl:0
    v_mfma_f32_32x32x16_bf16 a[32:47], a[172:175], v[88:91], a[32:47]
    v_and_b32_dpp v160, v88, v4 wave_shr:1 row_mask:0xf bank_mask:0xf bound_ctrl:0
    v_and_b32_dpp v161, v89, v4 wave_shr:1 row_mask:0xf bank_mask:0xf bound_ctrl:0
    s_mov_b32 s38, 69632
    buffer_load_dwordx4 a[100:103], v3, s[16:19], s38 offen offset:1024 sc1
    s_waitcnt vmcnt(21)
    v_mfma_f32_32x32x16_bf16 a[48:63], a[172:175], v[92:95], a[48:63]
    v_and_b32_dpp v162, v90, v4 wave_shr:1 row_mask:0xf bank_mask:0xf bound_ctrl:0
    v_and_b32_dpp v163, v91, v4 wave_shr:1 row_mask:0xf bank_mask:0xf bound_ctrl:0
    buffer_load_dwordx4 v[96:99], v9, s[12:15], s43 offen offset:2048 sc1
    s_waitcnt vmcnt(20)
    v_mfma_f32_32x32x16_bf16 a[0:15], a[180:183], v[128:131], a[0:15]
    v_and_b32_dpp v164, v92, v4 wave_shr:1 row_mask:0xf bank_mask:0xf bound_ctrl:0
    v_and_b32_dpp v165, v93, v4 wave_shr:1 row_mask:0xf bank_mask:0xf bound_ctrl:0
    s_waitcnt vmcnt(19)
    v_mfma_f32_32x32x16_bf16 a[16:31], a[180:183], v[132:135], a[16:31]
    v_and_b32_dpp v166, v94, v4 wave_shr:1 row_mask:0xf bank_mask:0xf bound_ctrl:0
    v_and_b32_dpp v167, v95, v4 wave_shr:1 row_mask:0xf bank_mask:0xf bound_ctrl:0
    buffer_load_dwordx4 v[100:103], v10, s[12:15], s43 offen offset:2048 sc1
    s_waitcnt vmcnt(19)
    v_mfma_f32_32x32x16_bf16 a[32:47], a[180:183], v[136:139], a[32:47]
    s_waitcnt vmcnt(18)
    v_mfma_f32_32x32x16_bf16 a[48:63], a[180:183], v[140:143], a[48:63]
    buffer_load_dwordx4 v[104:107], v11, s[12:15], s43 offen offset:2048 sc1
    s_waitcnt vmcnt(18)
    v_mfma_f32_32x32x16_bf16 a[0:15], a[144:147], v[144:147], a[0:15]
    v_and_b32_dpp v168, v72, v5 wave_shl:1 row_mask:0xf bank_mask:0xf bound_ctrl:0
    v_and_b32_dpp v169, v73, v5 wave_shl:1 row_mask:0xf bank_mask:0xf bound_ctrl:0
    v_and_b32_dpp v170, v74, v5 wave_shl:1 row_mask:0xf bank_mask:0xf bound_ctrl:0
    v_mfma_f32_32x32x16_bf16 a[16:31], a[144:147], v[148:151], a[16:31]
    v_and_b32_dpp v171, v75, v5 wave_shl:1 row_mask:0xf bank_mask:0xf bound_ctrl:0
    v_and_b32_dpp v172, v76, v5 wave_shl:1 row_mask:0xf bank_mask:0xf bound_ctrl:0
    v_and_b32_dpp v173, v77, v5 wave_shl:1 row_mask:0xf bank_mask:0xf bound_ctrl:0
    buffer_load_dwordx4 v[108:111], v12, s[12:15], s43 offen offset:2048 sc1
    v_mfma_f32_32x32x16_bf16 a[32:47], a[144:147], v[152:155], a[32:47]
    v_and_b32_dpp v174, v78, v5 wave_shl:1 row_mask:0xf bank_mask:0xf bound_ctrl:0
    v_and_b32_dpp v175, v79, v5 wave_shl:1 row_mask:0xf bank_mask:0xf bound_ctrl:0
    v_and_b32_dpp v176, v80, v5 wave_shl:1 row_mask:0xf bank_mask:0xf bound_ctrl:0
    v_mfma_f32_32x32x16_bf16 a[48:63], a[144:147], v[156:159], a[48:63]
    v_and_b32_dpp v177, v81, v5 wave_shl:1 row_mask:0xf bank_mask:0xf bound_ctrl:0
    v_and_b32_dpp v178, v82, v5 wave_shl:1 row_mask:0xf bank_mask:0xf bound_ctrl:0
    v_and_b32_dpp v179, v83, v5 wave_shl:1 row_mask:0xf bank_mask:0xf bound_ctrl:0
    s_mov_b32 s38, 61440
    buffer_load_dwordx4 a[64:67], v3, s[16:19], s38 offen offset:0 sc1
    s_waitcnt vmcnt(19)
    v_mfma_f32_32x32x16_bf16 a[0:15], a[156:159], v[148:151], a[0:15]
    v_and_b32_dpp v180, v84, v5 wave_shl:1 row_mask:0xf bank_mask:0xf bound_ctrl:0
    v_and_b32_dpp v181, v85, v5 wave_shl:1 row_mask:0xf bank_mask:0xf bound_ctrl:0
    v_and_b32_dpp v182, v86, v5 wave_shl:1 row_mask:0xf bank_mask:0xf bound_ctrl:0
    s_mov_b32 s38, 61440
    buffer_load_dwordx4 a[76:79], v3, s[16:19], s38 offen offset:3072 sc1
    v_mfma_f32_32x32x16_bf16 a[16:31], a[156:159], v[152:155], a[16:31]
    v_and_b32_dpp v183, v87, v5 wave_shl:1 row_mask:0xf bank_mask:0xf bound_ctrl:0
    v_and_b32_dpp v184, v88, v5 wave_shl:1 row_mask:0xf bank_mask:0xf bound_ctrl:0
    v_and_b32_dpp v185, v89, v5 wave_shl:1 row_mask:0xf bank_mask:0xf bound_ctrl:0
    v_mfma_f32_32x32x16_bf16 a[32:47], a[156:159], v[156:159], a[32:47]
    v_and_b32_dpp v186, v90, v5 wave_shl:1 row_mask:0xf bank_mask:0xf bound_ctrl:0
    v_and_b32_dpp v187, v91, v5 wave_shl:1 row_mask:0xf bank_mask:0xf bound_ctrl:0
    v_and_b32_dpp v188, v92, v5 wave_shl:1 row_mask:0xf bank_mask:0xf bound_ctrl:0
    s_mov_b32 s38, 65536
    buffer_load_dwordx4 a[88:91], v3, s[16:19], s38 offen offset:2048 sc1
    v_mfma_f32_32x32x16_bf16 a[48:63], a[156:159], v[160:163], a[48:63]
    v_and_b32_dpp v189, v93, v5 wave_shl:1 row_mask:0xf bank_mask:0xf bound_ctrl:0
    v_and_b32_dpp v190, v94, v5 wave_shl:1 row_mask:0xf bank_mask:0xf bound_ctrl:0
    v_and_b32_dpp v191, v95, v5 wave_shl:1 row_mask:0xf bank_mask:0xf bound_ctrl:0
    s_waitcnt vmcnt(20)
    v_mfma_f32_32x32x16_bf16 a[0:15], a[168:171], v[152:155], a[0:15]
    s_mov_b32 s38, 61440
    buffer_load_dwordx4 a[72:75], v3, s[16:19], s38 offen offset:2048 sc1
    v_mfma_f32_32x32x16_bf16 a[16:31], a[168:171], v[156:159], a[16:31]
    v_mfma_f32_32x32x16_bf16 a[32:47], a[168:171], v[160:163], a[32:47]
    s_mov_b32 s38, 65536
    buffer_load_dwordx4 a[84:87], v3, s[16:19], s38 offen offset:1024 sc1
    v_mfma_f32_32x32x16_bf16 a[48:63], a[168:171], v[164:167], a[48:63]
    s_waitcnt vmcnt(21)
    v_mfma_f32_32x32x16_bf16 a[0:15], a[152:155], v[168:171], a[0:15]
    s_mov_b32 s38, 69632
    buffer_load_dwordx4 a[96:99], v3, s[16:19], s38 offen offset:0 sc1
    v_mfma_f32_32x32x16_bf16 a[16:31], a[152:155], v[172:175], a[16:31]
    v_mfma_f32_32x32x16_bf16 a[32:47], a[152:155], v[176:179], a[32:47]
    s_mov_b32 s38, 69632
    buffer_load_dwordx4 a[108:111], v3, s[16:19], s38 offen offset:3072 sc1
    v_mfma_f32_32x32x16_bf16 a[48:63], a[152:155], v[180:183], a[48:63]
    buffer_load_dwordx4 v[48:51], v8, s[12:15], s33 offen offset:3072 sc1
    s_waitcnt vmcnt(23)
    v_mfma_f32_32x32x16_bf16 a[0:15], a[164:167], v[172:175], a[0:15]
    v_mfma_f32_32x32x16_bf16 a[16:31], a[164:167], v[176:179], a[16:31]
    buffer_load_dwordx4 v[52:55], v9, s[12:15], s33 offen offset:3072 sc1
    v_mfma_f32_32x32x16_bf16 a[32:47], a[164:167], v[180:183], a[32:47]
    v_mfma_f32_32x32x16_bf16 a[48:63], a[164:167], v[184:187], a[48:63]
    buffer_load_dwordx4 v[56:59], v10, s[12:15], s33 offen offset:3072 sc1
    s_waitcnt vmcnt(24)
    v_mfma_f32_32x32x16_bf16 a[0:15], a[176:179], v[176:179], a[0:15]
    v_mfma_f32_32x32x16_bf16 a[16:31], a[176:179], v[180:183], a[16:31]
    buffer_load_dwordx4 v[60:63], v11, s[12:15], s33 offen offset:3072 sc1
    v_mfma_f32_32x32x16_bf16 a[32:47], a[176:179], v[184:187], a[32:47]
    v_mfma_f32_32x32x16_bf16 a[48:63], a[176:179], v[188:191], a[48:63]
    s_mov_b32 s38, 73728
    buffer_load_dwordx4 a[120:123], v3, s[16:19], s38 offen offset:2048 sc1
    buffer_load_dwordx4 v[16:19], v6, s[20:23], 0 offen
    buffer_load_dwordx4 v[20:23], v6, s[20:23], s39 offen
    s_waitcnt vmcnt(26)
    v_mfma_f32_32x32x16_bf16 a[0:15], a[68:71], v[24:27], a[0:15]
    buffer_load_dwordx4 v[64:67], v12, s[12:15], s33 offen offset:3072 sc1
    s_waitcnt vmcnt(26)
    v_mfma_f32_32x32x16_bf16 a[16:31], a[68:71], v[28:31], a[16:31]
    s_waitcnt vmcnt(25)
    v_mfma_f32_32x32x16_bf16 a[32:47], a[68:71], v[32:35], a[32:47]
    v_and_b32_dpp v144, v24, v4 wave_shr:1 row_mask:0xf bank_mask:0xf bound_ctrl:0
    v_and_b32_dpp v145, v25, v4 wave_shr:1 row_mask:0xf bank_mask:0xf bound_ctrl:0
    s_mov_b32 s38, 77824
    buffer_load_dwordx4 a[132:135], v3, s[16:19], s38 offen offset:1024 sc1
    s_waitcnt vmcnt(25)
    v_mfma_f32_32x32x16_bf16 a[48:63], a[68:71], v[36:39], a[48:63]
    v_and_b32_dpp v146, v26, v4 wave_shr:1 row_mask:0xf bank_mask:0xf bound_ctrl:0
    v_and_b32_dpp v147, v27, v4 wave_shr:1 row_mask:0xf bank_mask:0xf bound_ctrl:0
    s_waitcnt vmcnt(24)
    v_mfma_f32_32x32x16_bf16 a[0:15], a[80:83], v[28:31], a[0:15]
    v_and_b32_dpp v148, v28, v4 wave_shr:1 row_mask:0xf bank_mask:0xf bound_ctrl:0
    v_and_b32_dpp v149, v29, v4 wave_shr:1 row_mask:0xf bank_mask:0xf bound_ctrl:0
    buffer_load_dwordx4 v[68:71], v13, s[12:15], s33 offen offset:3072 sc1
    v_mfma_f32_32x32x16_bf16 a[16:31], a[80:83], v[32:35], a[16:31]
    v_and_b32_dpp v150, v30, v4 wave_shr:1 row_mask:0xf bank_mask:0xf bound_ctrl:0
    v_and_b32_dpp v151, v31, v4 wave_shr:1 row_mask:0xf bank_mask:0xf bound_ctrl:0
    v_mfma_f32_32x32x16_bf16 a[32:47], a[80:83], v[36:39], a[32:47]
    v_and_b32_dpp v152, v32, v4 wave_shr:1 row_mask:0xf bank_mask:0xf bound_ctrl:0
    v_and_b32_dpp v153, v33, v4 wave_shr:1 row_mask:0xf bank_mask:0xf bound_ctrl:0
    s_mov_b32 s38, 77824
    buffer_load_dwordx4 a[140:143], v3, s[16:19], s38 offen offset:3072 sc1
    s_waitcnt vmcnt(25)
    v_mfma_f32_32x32x16_bf16 a[48:63], a[80:83], v[40:43], a[48:63]
    v_and_b32_dpp v154, v34, v4 wave_shr:1 row_mask:0xf bank_mask:0xf bound_ctrl:0
    v_and_b32_dpp v155, v35, v4 wave_shr:1 row_mask:0xf bank_mask:0xf bound_ctrl:0
    s_waitcnt vmcnt(24)
    v_mfma_f32_32x32x16_bf16 a[0:15], a[92:95], v[32:35], a[0:15]
    v_and_b32_dpp v156, v36, v4 wave_shr:1 row_mask:0xf bank_mask:0xf bound_ctrl:0
    v_and_b32_dpp v157, v37, v4 wave_shr:1 row_mask:0xf bank_mask:0xf bound_ctrl:0
    buffer_load_dwordx4 v[112:115], v9, s[12:15], s43 offen offset:3072 sc1
    v_mfma_f32_32x32x16_bf16 a[16:31], a[92:95], v[36:39], a[16:31]
    v_and_b32_dpp v158, v38, v4 wave_shr:1 row_mask:0xf bank_mask:0xf bound_ctrl:0
    v_and_b32_dpp v159, v39, v4 wave_shr:1 row_mask:0xf bank_mask:0xf bound_ctrl:0
    v_mfma_f32_32x32x16_bf16 a[32:47], a[92:95], v[40:43], a[32:47]
    v_and_b32_dpp v160, v40, v4 wave_shr:1 row_mask:0xf bank_mask:0xf bound_ctrl:0
    v_and_b32_dpp v161, v41, v4 wave_shr:1 row_mask:0xf bank_mask:0xf bound_ctrl:0
    buffer_load_dwordx4 v[116:119], v10, s[12:15], s43 offen offset:3072 sc1
    s_waitcnt vmcnt(25)
    v_mfma_f32_32x32x16_bf16 a[48:63], a[92:95], v[44:47], a[48:63]
    v_and_b32_dpp v162, v42, v4 wave_shr:1 row_mask:0xf bank_mask:0xf bound_ctrl:0
    v_and_b32_dpp v163, v43, v4 wave_shr:1 row_mask:0xf bank_mask:0xf bound_ctrl:0
    buffer_load_dwordx4 v[120:123], v11, s[12:15], s43 offen offset:3072 sc1
    s_waitcnt vmcnt(24)
    v_mfma_f32_32x32x16_bf16 a[0:15], a[100:103], v[96:99], a[0:15]
    v_and_b32_dpp v164, v44, v4 wave_shr:1 row_mask:0xf bank_mask:0xf bound_ctrl:0
    v_and_b32_dpp v165, v45, v4 wave_shr:1 row_mask:0xf bank_mask:0xf bound_ctrl:0
    s_waitcnt vmcnt(23)
    v_mfma_f32_32x32x16_bf16 a[16:31], a[100:103], v[100:103], a[16:31]
    v_and_b32_dpp v166, v46, v4 wave_shr:1 row_mask:0xf bank_mask:0xf bound_ctrl:0
    v_and_b32_dpp v167, v47, v4 wave_shr:1 row_mask:0xf bank_mask:0xf bound_ctrl:0
    buffer_load_dwordx4 v[124:127], v12, s[12:15], s43 offen offset:3072 sc1
    s_waitcnt vmcnt(23)
    v_mfma_f32_32x32x16_bf16 a[32:47], a[100:103], v[104:107], a[32:47]
    s_waitcnt vmcnt(22)
    v_mfma_f32_32x32x16_bf16 a[48:63], a[100:103], v[108:111], a[48:63]
    s_mov_b32 s38, 69632
    buffer_load_dwordx4 a[104:107], v3, s[16:19], s38 offen offset:2048 sc1
    s_waitcnt vmcnt(22)
    v_mfma_f32_32x32x16_bf16 a[0:15], a[64:67], v[144:147], a[0:15]
    v_and_b32_dpp v168, v24, v5 wave_shl:1 row_mask:0xf bank_mask:0xf bound_ctrl:0
    v_and_b32_dpp v169, v25, v5 wave_shl:1 row_mask:0xf bank_mask:0xf bound_ctrl:0
    v_and_b32_dpp v170, v26, v5 wave_shl:1 row_mask:0xf bank_mask:0xf bound_ctrl:0
    v_mfma_f32_32x32x16_bf16 a[16:31], a[64:67], v[148:151], a[16:31]
    v_and_b32_dpp v171, v27, v5 wave_shl:1 row_mask:0xf bank_mask:0xf bound_ctrl:0
    v_and_b32_dpp v172, v28, v5 wave_shl:1 row_mask:0xf bank_mask:0xf bound_ctrl:0
    v_and_b32_dpp v173, v29, v5 wave_shl:1 row_mask:0xf bank_mask:0xf bound_ctrl:0
    s_mov_b32 s38, 73728
    buffer_load_dwordx4 a[116:119], v3, s[16:19], s38 offen offset:1024 sc1
    v_mfma_f32_32x32x16_bf16 a[32:47], a[64:67], v[152:155], a[32:47]
    v_and_b32_dpp v174, v30, v5 wave_shl:1 row_mask:0xf bank_mask:0xf bound_ctrl:0
    v_and_b32_dpp v175, v31, v5 wave_shl:1 row_mask:0xf bank_mask:0xf bound_ctrl:0
    v_and_b32_dpp v176, v32, v5 wave_shl:1 row_mask:0xf bank_mask:0xf bound_ctrl:0
    v_mfma_f32_32x32x16_bf16 a[48:63], a[64:67], v[156:159], a[48:63]
    v_and_b32_dpp v177, v33, v5 wave_shl:1 row_mask:0xf bank_mask:0xf bound_ctrl:0
    v_and_b32_dpp v178, v34, v5 wave_shl:1 row_mask:0xf bank_mask:0xf bound_ctrl:0
    v_and_b32_dpp v179, v35, v5 wave_shl:1 row_mask:0xf bank_mask:0xf bound_ctrl:0
    s_mov_b32 s38, 77824
    buffer_load_dwordx4 a[128:131], v3, s[16:19], s38 offen offset:0 sc1
    s_waitcnt vmcnt(23)
    v_mfma_f32_32x32x16_bf16 a[0:15], a[76:79], v[148:151], a[0:15]
    v_and_b32_dpp v180, v36, v5 wave_shl:1 row_mask:0xf bank_mask:0xf bound_ctrl:0
    v_and_b32_dpp v181, v37, v5 wave_shl:1 row_mask:0xf bank_mask:0xf bound_ctrl:0
    v_and_b32_dpp v182, v38, v5 wave_shl:1 row_mask:0xf bank_mask:0xf bound_ctrl:0
    s_mov_b32 s38, 73728
    buffer_load_dwordx4 a[112:115], v3, s[16:19], s38 offen offset:0 sc1
    v_mfma_f32_32x32x16_bf16 a[16:31], a[76:79], v[152:155], a[16:31]
    v_and_b32_dpp v183, v39, v5 wave_shl:1 row_mask:0xf bank_mask:0xf bound_ctrl:0
    v_and_b32_dpp v184, v40, v5 wave_shl:1 row_mask:0xf bank_mask:0xf bound_ctrl:0
    v_and_b32_dpp v185, v41, v5 wave_shl:1 row_mask:0xf bank_mask:0xf bound_ctrl:0
    v_mfma_f32_32x32x16_bf16 a[32:47], a[76:79], v[156:159], a[32:47]
    v_and_b32_dpp v186, v42, v5 wave_shl:1 row_mask:0xf bank_mask:0xf bound_ctrl:0
    v_and_b32_dpp v187, v43, v5 wave_shl:1 row_mask:0xf bank_mask:0xf bound_ctrl:0
    v_and_b32_dpp v188, v44, v5 wave_shl:1 row_mask:0xf bank_mask:0xf bound_ctrl:0
    s_mov_b32 s38, 73728
    buffer_load_dwordx4 a[124:127], v3, s[16:19], s38 offen offset:3072 sc1
    v_mfma_f32_32x32x16_bf16 a[48:63], a[76:79], v[160:163], a[48:63]
    v_and_b32_dpp v189, v45, v5 wave_shl:1 row_mask:0xf bank_mask:0xf bound_ctrl:0
    v_and_b32_dpp v190, v46, v5 wave_shl:1 row_mask:0xf bank_mask:0xf bound_ctrl:0
    v_and_b32_dpp v191, v47, v5 wave_shl:1 row_mask:0xf bank_mask:0xf bound_ctrl:0
    s_waitcnt vmcnt(24)
    v_mfma_f32_32x32x16_bf16 a[0:15], a[88:91], v[152:155], a[0:15]
    s_mov_b32 s38, 77824
    buffer_load_dwordx4 a[136:139], v3, s[16:19], s38 offen offset:2048 sc1
    v_mfma_f32_32x32x16_bf16 a[16:31], a[88:91], v[156:159], a[16:31]
    v_mfma_f32_32x32x16_bf16 a[32:47], a[88:91], v[160:163], a[32:47]
    v_mfma_f32_32x32x16_bf16 a[48:63], a[88:91], v[164:167], a[48:63]
    s_waitcnt vmcnt(24)
    v_mfma_f32_32x32x16_bf16 a[0:15], a[72:75], v[168:171], a[0:15]
    v_mfma_f32_32x32x16_bf16 a[16:31], a[72:75], v[172:175], a[16:31]
    v_mfma_f32_32x32x16_bf16 a[32:47], a[72:75], v[176:179], a[32:47]
    v_mfma_f32_32x32x16_bf16 a[48:63], a[72:75], v[180:183], a[48:63]
    s_waitcnt vmcnt(23)
    v_mfma_f32_32x32x16_bf16 a[0:15], a[84:87], v[172:175], a[0:15]
    v_mfma_f32_32x32x16_bf16 a[16:31], a[84:87], v[176:179], a[16:31]
    v_mfma_f32_32x32x16_bf16 a[32:47], a[84:87], v[180:183], a[32:47]
    v_mfma_f32_32x32x16_bf16 a[48:63], a[84:87], v[184:187], a[48:63]
    s_waitcnt vmcnt(22)
    v_mfma_f32_32x32x16_bf16 a[0:15], a[96:99], v[176:179], a[0:15]
    v_mfma_f32_32x32x16_bf16 a[16:31], a[96:99], v[180:183], a[16:31]
    v_mfma_f32_32x32x16_bf16 a[32:47], a[96:99], v[184:187], a[32:47]
    v_mfma_f32_32x32x16_bf16 a[48:63], a[96:99], v[188:191], a[48:63]
    s_waitcnt vmcnt(20)
    v_mfma_f32_32x32x16_bf16 a[0:15], a[108:111], v[48:51], a[0:15]
    s_waitcnt vmcnt(19)
    v_mfma_f32_32x32x16_bf16 a[16:31], a[108:111], v[52:55], a[16:31]
    s_waitcnt vmcnt(18)
    v_mfma_f32_32x32x16_bf16 a[32:47], a[108:111], v[56:59], a[32:47]
    v_and_b32_dpp v144, v48, v4 wave_shr:1 row_mask:0xf bank_mask:0xf bound_ctrl:0
    v_and_b32_dpp v168, v48, v5 wave_shl:1 row_mask:0xf bank_mask:0xf bound_ctrl:0
    v_and_b32_dpp v145, v49, v4 wave_shr:1 row_mask:0xf bank_mask:0xf bound_ctrl:0
    v_and_b32_dpp v169, v49, v5 wave_shl:1 row_mask:0xf bank_mask:0xf bound_ctrl:0
    s_waitcnt vmcnt(17)
    v_mfma_f32_32x32x16_bf16 a[48:63], a[108:111], v[60:63], a[48:63]
    v_and_b32_dpp v146, v50, v4 wave_shr:1 row_mask:0xf bank_mask:0xf bound_ctrl:0
    v_and_b32_dpp v170, v50, v5 wave_shl:1 row_mask:0xf bank_mask:0xf bound_ctrl:0
    v_and_b32_dpp v147, v51, v4 wave_shr:1 row_mask:0xf bank_mask:0xf bound_ctrl:0
    v_and_b32_dpp v171, v51, v5 wave_shl:1 row_mask:0xf bank_mask:0xf bound_ctrl:0
    s_waitcnt vmcnt(16)
    v_mfma_f32_32x32x16_bf16 a[0:15], a[120:123], v[52:55], a[0:15]
    v_and_b32_dpp v148, v52, v4 wave_shr:1 row_mask:0xf bank_mask:0xf bound_ctrl:0
    v_and_b32_dpp v172, v52, v5 wave_shl:1 row_mask:0xf bank_mask:0xf bound_ctrl:0
    v_and_b32_dpp v149, v53, v4 wave_shr:1 row_mask:0xf bank_mask:0xf bound_ctrl:0
    v_and_b32_dpp v173, v53, v5 wave_shl:1 row_mask:0xf bank_mask:0xf bound_ctrl:0
    v_mfma_f32_32x32x16_bf16 a[16:31], a[120:123], v[56:59], a[16:31]
    v_and_b32_dpp v150, v54, v4 wave_shr:1 row_mask:0xf bank_mask:0xf bound_ctrl:0
    v_and_b32_dpp v174, v54, v5 wave_shl:1 row_mask:0xf bank_mask:0xf bound_ctrl:0
    v_and_b32_dpp v151, v55, v4 wave_shr:1 row_mask:0xf bank_mask:0xf bound_ctrl:0
    v_and_b32_dpp v175, v55, v5 wave_shl:1 row_mask:0xf bank_mask:0xf bound_ctrl:0
    v_mfma_f32_32x32x16_bf16 a[32:47], a[120:123], v[60:63], a[32:47]
    v_and_b32_dpp v152, v56, v4 wave_shr:1 row_mask:0xf bank_mask:0xf bound_ctrl:0
    v_and_b32_dpp v176, v56, v5 wave_shl:1 row_mask:0xf bank_mask:0xf bound_ctrl:0
    v_and_b32_dpp v153, v57, v4 wave_shr:1 row_mask:0xf bank_mask:0xf bound_ctrl:0
    v_and_b32_dpp v177, v57, v5 wave_shl:1 row_mask:0xf bank_mask:0xf bound_ctrl:0
    s_waitcnt vmcnt(13)
    v_mfma_f32_32x32x16_bf16 a[48:63], a[120:123], v[64:67], a[48:63]
    v_and_b32_dpp v154, v58, v4 wave_shr:1 row_mask:0xf bank_mask:0xf bound_ctrl:0
    v_and_b32_dpp v178, v58, v5 wave_shl:1 row_mask:0xf bank_mask:0xf bound_ctrl:0
    v_and_b32_dpp v155, v59, v4 wave_shr:1 row_mask:0xf bank_mask:0xf bound_ctrl:0
    v_and_b32_dpp v179, v59, v5 wave_shl:1 row_mask:0xf bank_mask:0xf bound_ctrl:0
    s_waitcnt vmcnt(12)
    v_mfma_f32_32x32x16_bf16 a[0:15], a[132:135], v[56:59], a[0:15]
    v_and_b32_dpp v156, v60, v4 wave_shr:1 row_mask:0xf bank_mask:0xf bound_ctrl:0
    v_and_b32_dpp v180, v60, v5 wave_shl:1 row_mask:0xf bank_mask:0xf bound_ctrl:0
    v_and_b32_dpp v157, v61, v4 wave_shr:1 row_mask:0xf bank_mask:0xf bound_ctrl:0
    v_and_b32_dpp v181, v61, v5 wave_shl:1 row_mask:0xf bank_mask:0xf bound_ctrl:0
    v_mfma_f32_32x32x16_bf16 a[16:31], a[132:135], v[60:63], a[16:31]
    v_and_b32_dpp v158, v62, v4 wave_shr:1 row_mask:0xf bank_mask:0xf bound_ctrl:0
    v_and_b32_dpp v182, v62, v5 wave_shl:1 row_mask:0xf bank_mask:0xf bound_ctrl:0
    v_and_b32_dpp v159, v63, v4 wave_shr:1 row_mask:0xf bank_mask:0xf bound_ctrl:0
    v_and_b32_dpp v183, v63, v5 wave_shl:1 row_mask:0xf bank_mask:0xf bound_ctrl:0
    v_mfma_f32_32x32x16_bf16 a[32:47], a[132:135], v[64:67], a[32:47]
    v_and_b32_dpp v160, v64, v4 wave_shr:1 row_mask:0xf bank_mask:0xf bound_ctrl:0
    v_and_b32_dpp v184, v64, v5 wave_shl:1 row_mask:0xf bank_mask:0xf bound_ctrl:0
    v_and_b32_dpp v161, v65, v4 wave_shr:1 row_mask:0xf bank_mask:0xf bound_ctrl:0
    v_and_b32_dpp v185, v65, v5 wave_shl:1 row_mask:0xf bank_mask:0xf bound_ctrl:0
    s_waitcnt vmcnt(11)
    v_mfma_f32_32x32x16_bf16 a[48:63], a[132:135], v[68:71], a[48:63]
    v_and_b32_dpp v162, v66, v4 wave_shr:1 row_mask:0xf bank_mask:0xf bound_ctrl:0
    v_and_b32_dpp v186, v66, v5 wave_shl:1 row_mask:0xf bank_mask:0xf bound_ctrl:0
    v_and_b32_dpp v163, v67, v4 wave_shr:1 row_mask:0xf bank_mask:0xf bound_ctrl:0
    v_and_b32_dpp v187, v67, v5 wave_shl:1 row_mask:0xf bank_mask:0xf bound_ctrl:0
    s_waitcnt vmcnt(9)
    v_mfma_f32_32x32x16_bf16 a[0:15], a[140:143], v[112:115], a[0:15]
    v_and_b32_dpp v164, v68, v4 wave_shr:1 row_mask:0xf bank_mask:0xf bound_ctrl:0
    v_and_b32_dpp v188, v68, v5 wave_shl:1 row_mask:0xf bank_mask:0xf bound_ctrl:0
    v_and_b32_dpp v165, v69, v4 wave_shr:1 row_mask:0xf bank_mask:0xf bound_ctrl:0
    v_and_b32_dpp v189, v69, v5 wave_shl:1 row_mask:0xf bank_mask:0xf bound_ctrl:0
    s_waitcnt vmcnt(8)
    v_mfma_f32_32x32x16_bf16 a[16:31], a[140:143], v[116:119], a[16:31]
    v_and_b32_dpp v166, v70, v4 wave_shr:1 row_mask:0xf bank_mask:0xf bound_ctrl:0
    v_and_b32_dpp v190, v70, v5 wave_shl:1 row_mask:0xf bank_mask:0xf bound_ctrl:0
    v_and_b32_dpp v167, v71, v4 wave_shr:1 row_mask:0xf bank_mask:0xf bound_ctrl:0
    v_and_b32_dpp v191, v71, v5 wave_shl:1 row_mask:0xf bank_mask:0xf bound_ctrl:0
    s_waitcnt vmcnt(7)
    v_mfma_f32_32x32x16_bf16 a[32:47], a[140:143], v[120:123], a[32:47]
    s_waitcnt vmcnt(6)
    v_mfma_f32_32x32x16_bf16 a[48:63], a[140:143], v[124:127], a[48:63]
    s_waitcnt vmcnt(5)
    v_mfma_f32_32x32x16_bf16 a[0:15], a[104:107], v[144:147], a[0:15]
    s_waitcnt vmcnt(4)
    v_mfma_f32_32x32x16_bf16 a[0:15], a[116:119], v[148:151], a[0:15]
    s_waitcnt vmcnt(3)
    v_mfma_f32_32x32x16_bf16 a[0:15], a[128:131], v[152:155], a[0:15]
    s_waitcnt vmcnt(2)
    v_mfma_f32_32x32x16_bf16 a[0:15], a[112:115], v[168:171], a[0:15]
    s_waitcnt vmcnt(1)
    v_mfma_f32_32x32x16_bf16 a[0:15], a[124:127], v[172:175], a[0:15]
    s_waitcnt vmcnt(0)
    v_mfma_f32_32x32x16_bf16 a[0:15], a[136:139], v[176:179], a[0:15]
    v_mfma_f32_32x32x16_bf16 a[16:31], a[104:107], v[148:151], a[16:31]
    v_mfma_f32_32x32x16_bf16 a[16:31], a[116:119], v[152:155], a[16:31]
    s_nop 9
    ds_write_b128 v14, a[0:3] offset:0
    v_mfma_f32_32x32x16_bf16 a[16:31], a[128:131], v[156:159], a[16:31]
    ds_write_b128 v14, a[4:7] offset:1088
    v_mfma_f32_32x32x16_bf16 a[16:31], a[112:115], v[172:175], a[16:31]
    ds_write_b128 v14, a[8:11] offset:2176
    v_mfma_f32_32x32x16_bf16 a[16:31], a[124:127], v[176:179], a[16:31]
    ds_write_b128 v14, a[12:15] offset:3264
    v_mfma_f32_32x32x16_bf16 a[16:31], a[136:139], v[180:183], a[16:31]
    v_mfma_f32_32x32x16_bf16 a[32:47], a[104:107], v[152:155], a[32:47]
    v_mfma_f32_32x32x16_bf16 a[32:47], a[116:119], v[156:159], a[32:47]
    s_nop 9
    ds_write_b128 v14, a[16:19] offset:17408
    v_mfma_f32_32x32x16_bf16 a[32:47], a[128:131], v[160:163], a[32:47]
    ds_write_b128 v14, a[20:23] offset:18496
    v_mfma_f32_32x32x16_bf16 a[32:47], a[112:115], v[176:179], a[32:47]
    ds_write_b128 v14, a[24:27] offset:19584
    v_mfma_f32_32x32x16_bf16 a[32:47], a[124:127], v[180:183], a[32:47]
    ds_write_b128 v14, a[28:31] offset:20672
    v_mfma_f32_32x32x16_bf16 a[32:47], a[136:139], v[184:187], a[32:47]
    v_mfma_f32_32x32x16_bf16 a[48:63], a[104:107], v[156:159], a[48:63]
    v_mfma_f32_32x32x16_bf16 a[48:63], a[116:119], v[160:163], a[48:63]
    s_nop 9
    ds_write_b128 v14, a[32:35] offset:34816
    v_mfma_f32_32x32x16_bf16 a[48:63], a[128:131], v[164:167], a[48:63]
    ds_write_b128 v14, a[36:39] offset:35904
    v_mfma_f32_32x32x16_bf16 a[48:63], a[112:115], v[180:183], a[48:63]
    ds_write_b128 v14, a[40:43] offset:36992
    v_mfma_f32_32x32x16_bf16 a[48:63], a[124:127], v[184:187], a[48:63]
    ds_write_b128 v14, a[44:47] offset:38080
    v_mfma_f32_32x32x16_bf16 a[48:63], a[136:139], v[188:191], a[48:63]
    s_nop 11
    ds_write_b128 v14, a[48:51] offset:52224
    ds_write_b128 v14, a[52:55] offset:53312
    ds_write_b128 v14, a[56:59] offset:54400
    ds_write_b128 v14, a[60:63] offset:55488
    s_waitcnt lgkmcnt(0)
    s_barrier
    ds_read_b128 v[24:27], v15 offset:0
    ds_read_b128 v[28:31], v15 offset:512
    ds_read_b128 v[32:35], v15 offset:4352
    ds_read_b128 v[36:39], v15 offset:4864
    ds_read_b128 v[40:43], v15 offset:8704
    ds_read_b128 v[44:47], v15 offset:9216
    ds_read_b128 v[48:51], v15 offset:13056
    ds_read_b128 v[52:55], v15 offset:13568
    ds_read_b128 v[56:59], v15 offset:256
    ds_read_b128 v[60:63], v15 offset:768
    ds_read_b128 v[64:67], v15 offset:4608
    ds_read_b128 v[68:71], v15 offset:5120
    ds_read_b128 v[72:75], v15 offset:8960
    ds_read_b128 v[76:79], v15 offset:9472
    ds_read_b128 v[80:83], v15 offset:13312
    ds_read_b128 v[84:87], v15 offset:13824
    s_waitcnt vmcnt(0)
    v_lshlrev_b32 v88, 16, v16
    v_and_b32 v89, 0xffff0000, v16
    v_lshlrev_b32 v90, 16, v17
    v_and_b32 v91, 0xffff0000, v17
    v_lshlrev_b32 v92, 16, v18
    v_and_b32 v93, 0xffff0000, v18
    v_lshlrev_b32 v94, 16, v19
    v_and_b32 v95, 0xffff0000, v19
    v_lshlrev_b32 v96, 16, v20
    v_and_b32 v97, 0xffff0000, v20
    v_lshlrev_b32 v98, 16, v21
    v_and_b32 v99, 0xffff0000, v21
    v_lshlrev_b32 v100, 16, v22
    v_and_b32 v101, 0xffff0000, v22
    v_lshlrev_b32 v102, 16, v23
    v_and_b32 v103, 0xffff0000, v23
    s_waitcnt lgkmcnt(14)
    v_pk_add_f32 v[88:89], v[88:89], v[24:25]
    v_pk_add_f32 v[90:91], v[90:91], v[26:27]
    v_pk_add_f32 v[92:93], v[92:93], v[28:29]
    v_pk_add_f32 v[94:95], v[94:95], v[30:31]
    s_waitcnt lgkmcnt(12)
    v_pk_add_f32 v[88:89], v[88:89], v[32:33]
    v_pk_add_f32 v[90:91], v[90:91], v[34:35]
    v_pk_add_f32 v[92:93], v[92:93], v[36:37]
    v_pk_add_f32 v[94:95], v[94:95], v[38:39]
    s_waitcnt lgkmcnt(10)
    v_pk_add_f32 v[88:89], v[88:89], v[40:41]
    v_pk_add_f32 v[90:91], v[90:91], v[42:43]
    v_pk_add_f32 v[92:93], v[92:93], v[44:45]
    v_pk_add_f32 v[94:95], v[94:95], v[46:47]
    s_waitcnt lgkmcnt(8)
    v_pk_add_f32 v[88:89], v[88:89], v[48:49]
    v_pk_add_f32 v[90:91], v[90:91], v[50:51]
    v_pk_add_f32 v[92:93], v[92:93], v[52:53]
    v_pk_add_f32 v[94:95], v[94:95], v[54:55]
    v_cvt_pk_bf16_f32 v16, v88, v89
    v_cvt_pk_bf16_f32 v17, v90, v91
    v_cvt_pk_bf16_f32 v18, v92, v93
    v_cvt_pk_bf16_f32 v19, v94, v95
    buffer_store_dwordx4 v[16:19], v6, s[24:27], 0 offen sc1
    s_waitcnt lgkmcnt(6)
    v_pk_add_f32 v[96:97], v[96:97], v[56:57]
    v_pk_add_f32 v[98:99], v[98:99], v[58:59]
    v_pk_add_f32 v[100:101], v[100:101], v[60:61]
    v_pk_add_f32 v[102:103], v[102:103], v[62:63]
    s_waitcnt lgkmcnt(4)
    v_pk_add_f32 v[96:97], v[96:97], v[64:65]
    v_pk_add_f32 v[98:99], v[98:99], v[66:67]
    v_pk_add_f32 v[100:101], v[100:101], v[68:69]
    v_pk_add_f32 v[102:103], v[102:103], v[70:71]
    s_waitcnt lgkmcnt(2)
    v_pk_add_f32 v[96:97], v[96:97], v[72:73]
    v_pk_add_f32 v[98:99], v[98:99], v[74:75]
    v_pk_add_f32 v[100:101], v[100:101], v[76:77]
    v_pk_add_f32 v[102:103], v[102:103], v[78:79]
    s_waitcnt lgkmcnt(0)
    v_pk_add_f32 v[96:97], v[96:97], v[80:81]
    v_pk_add_f32 v[98:99], v[98:99], v[82:83]
    v_pk_add_f32 v[100:101], v[100:101], v[84:85]
    v_pk_add_f32 v[102:103], v[102:103], v[86:87]
    v_cvt_pk_bf16_f32 v20, v96, v97
    v_cvt_pk_bf16_f32 v21, v98, v99
    v_cvt_pk_bf16_f32 v22, v100, v101
    v_cvt_pk_bf16_f32 v23, v102, v103
    buffer_store_dwordx4 v[20:23], v6, s[24:27], s39 offen sc1
fused_kernel_end:
    s_endpgm
.section .rodata,"a"
.p2align 6
.amdhsa_kernel fused_kernel
  .amdhsa_next_free_vgpr 440
  .amdhsa_next_free_sgpr 100
  .amdhsa_accum_offset 256
  .amdhsa_group_segment_fixed_size 0
  .amdhsa_kernarg_size 72
  .amdhsa_user_sgpr_count 2
  .amdhsa_user_sgpr_kernarg_segment_ptr 1
  .amdhsa_system_sgpr_workgroup_id_x 1
.end_amdhsa_kernel
.text
```
